```python
import torch

def _softmax(x, axis=-1):
    return torch.softmax(x, dim=axis)
def _gelu(x):
    return torch.nn.functional.gelu(x, approximate="tanh")
def _silu(x):
    return torch.nn.functional.silu(x)
def _sigmoid(x):
    return torch.sigmoid(x)
def _layernorm(x, axis=-1, eps=1e-5):
    m = x.mean(dim=axis, keepdim=True)
    v = x.var(dim=axis, keepdim=True, unbiased=False)
    return (x - m) / torch.sqrt(v + eps)
def _scatter_add(tgt, idx, src, axis=0):
    return tgt.clone().index_add_(axis, idx, src)
def _segment_sum(src, seg, n):
    out = torch.zeros((n,) + src.shape[1:], dtype=src.dtype)
    return out.index_add_(0, seg, src)
def _pad(x, pw):
    flat = tuple(v for pair in reversed(pw) for v in pair)
    return torch.nn.functional.pad(x, flat)

kernel_name = 'parallel_sum__compressed_kv_cla__glu_gated_glu__decode'

def setup_inputs():

    _w = (lambda a: (lambda t: t.to(torch.bfloat16) if t.is_floating_point() else t)(torch.as_tensor(a)))
    def _A_setup():
        B, H, Sq, Sk, D, M = 2, 32, 1, 4096, 128, 512
        Dc = 4 * D
        return {
            "x": _w((lambda *s: torch.randn(*s, dtype=torch.bfloat16) * 0.05)(B, Sq, M)),
            "c_kv": _w((lambda *s: torch.randn(*s, dtype=torch.bfloat16) * 1.6)(B, Sk, Dc)),
            "w_q": _w((lambda *s: torch.randn(*s, dtype=torch.bfloat16) * 1.6)(M, H, D) * (M ** -0.5)),
            "w_uk": _w((lambda *s: torch.randn(*s, dtype=torch.bfloat16) * 1.6)(Dc, H, D) * (Dc ** -0.5)),
            "w_uv": _w((lambda *s: torch.randn(*s, dtype=torch.bfloat16) * 1.6)(Dc, H, D) * (Dc ** -0.5)),
            "w_o": _w((lambda *s: torch.randn(*s, dtype=torch.bfloat16) * 1.6)(H, D, M) * ((H * D) ** -0.5)),
        }
    _A_in = _A_setup()

    def _B_setup():
        B, S, D, F = 2, 1, 512, 1376
        return {
            "x": _w((lambda *s: torch.randn(*s, dtype=torch.bfloat16) * 0.05)(B, S, D)),
            "w_gate": _w((lambda *s: torch.randn(*s, dtype=torch.bfloat16) * 0.1)(D, F)),
            "w_up": _w((lambda *s: torch.randn(*s, dtype=torch.bfloat16) * 0.05)(D, F)),
            "w_down": _w((lambda *s: torch.randn(*s, dtype=torch.bfloat16) * 0.05)(F, D)),
        }
    _B_in = _B_setup()

    return {
        "A_x": _A_in["x"],
        "A_c_kv": _A_in["c_kv"],
        "A_w_q": _A_in["w_q"],
        "A_w_uk": _A_in["w_uk"],
        "A_w_uv": _A_in["w_uv"],
        "A_w_o": _A_in["w_o"],
        "B_x": _B_in["x"],
        "B_w_gate": _B_in["w_gate"],
        "B_w_up": _B_in["w_up"],
        "B_w_down": _B_in["w_down"],
    }

def reference(A_x, A_c_kv, A_w_q, A_w_uk, A_w_uv, A_w_o, B_x, B_w_gate, B_w_up, B_w_down):
    def _A_ref(x, c_kv, w_q, w_uk, w_uv, w_o):
        B, Sq, M = x.shape[0], x.shape[1], x.shape[2]
        Sk = c_kv.shape[1]
        H, D = w_q.shape[1], w_q.shape[2]
        q = torch.einsum("bqm,mhd->bhqd", x, w_q)
        k = torch.einsum("bkc,chd->bhkd", c_kv, w_uk)
        v = torch.einsum("bkc,chd->bhkd", c_kv, w_uv)
        scores = torch.einsum("bhqd,bhkd->bhqk", q, k) * (D ** -0.5)
        off = Sk - Sq
        qi = torch.arange(Sq)[:, None]
        kj = torch.arange(Sk)[None, :]
        cmask = kj <= (qi + off)
        scores = torch.where(cmask[None, None], scores, -1e9)
        p = _softmax(scores, axis=-1)
        ctx = torch.einsum("bhqk,bhkd->bhqd", p, v)
        return torch.einsum("bhqd,hdm->bqm", ctx, w_o)

    def _B_ref(x, w_gate, w_up, w_down):
        g = torch.einsum("bsd,df->bsf", x, w_gate)
        u = torch.einsum("bsd,df->bsf", x, w_up)
        h = _sigmoid(g) * u
        return torch.einsum("bsf,fd->bsd", h, w_down)

    x = A_x
    xn = _layernorm(x, axis=-1)
    return x + _A_ref(xn, A_c_kv, A_w_q, A_w_uk, A_w_uv, A_w_o) + _B_ref(xn, B_w_gate, B_w_up, B_w_down)
```

```asm
; @launch grid=(256,1,1) block=(512,1,1) lds=156928
.amdgcn_target "amdgcn-amd-amdhsa--gfx950"
.text
.globl parallel_sum__compressed_kv_cla__glu_gated_glu__decode_kernel
.p2align 8
.type parallel_sum__compressed_kv_cla__glu_gated_glu__decode_kernel,@function
parallel_sum__compressed_kv_cla__glu_gated_glu__decode_kernel:
    s_load_dwordx16 s[16:31], s[0:1], 0
    s_load_dwordx8 s[32:39], s[0:1], 64
    s_load_dwordx2 s[40:41], s[0:1], 96
    s_cmp_ge_u32 s2, 256
    s_cbranch_scc1 L_end
    v_lshrrev_b32 v4, 6, v0
    v_and_b32 v1, 63, v0
    v_readfirstlane_b32 s3, v4
    v_lshrrev_b32 v2, 4, v1
    v_and_b32 v3, 15, v1
    s_mov_b32 s46, 0x800000
    s_mov_b32 s47, 0x20000
    s_mov_b32 s50, 2048
    s_mov_b32 s51, 0x20000
    s_mov_b32 s54, 0x400000
    s_mov_b32 s55, 0x20000
    s_mov_b32 s59, 0x20000
    s_mov_b32 s63, 0x20000
    s_and_b32 s4, s2, 7
    s_lshr_b32 s5, s2, 3
    s_bfe_u32 s15, s5, 0x20002
    s_and_b32 s7, s5, 3
    s_lshr_b32 s96, s5, 4
    s_xor_b32 s96, s96, s15
    s_and_b32 s96, s96, 1
    s_lshl_b32 s96, s96, 2
    s_add_u32 s96, s96, s7
    s_lshl_b32 s6, s4, 2
    s_add_u32 s6, s6, s15
    s_cmp_lg_u32 s3, 0
    s_cbranch_scc1 L_not0
    s_cmp_lt_u32 s2, 128
    s_cselect_b32 s10, 2, 0
    s_xor_b32 s10, s10, s6
    s_lshl_b32 s13, s10, 3
    s_add_u32 s13, s13, s96
    s_lshl_b32 s13, s13, 10
    s_lshl_b32 s11, s96, 19
    s_lshl_b32 s10, s10, 8
    s_add_u32 s11, s11, s10
    s_lshl_b32 s12, s96, 7
    v_lshrrev_b32 v8, 3, v3
    v_lshlrev_b32 v8, 10, v8
    v_lshl_add_u32 v5, v2, 5, v8
    v_and_b32 v9, 7, v1
    v_lshl_add_u32 v9, v2, 3, v9
    v_lshl_add_u32 v4, v9, 4, v8
    v_lshlrev_b32 v6, 17, v2
    v_lshl_add_u32 v6, v3, 4, v6
    s_waitcnt lgkmcnt(0)
    s_mov_b64 s[48:49], s[16:17]
    s_mov_b64 s[52:53], s[20:21]
    buffer_load_dwordx4 v[8:11], v4, s[48:51], 0 offen
    buffer_load_dwordx4 v[12:15], v4, s[48:51], 0 offen offset:512
    buffer_load_dwordx4 v[16:19], v5, s[48:51], s12 offen
    buffer_load_dwordx4 v[20:23], v5, s[48:51], s12 offen offset:16
    buffer_load_dwordx4 v[24:27], v6, s[52:55], s11 offen
    s_add_u32 s11, s11, 8192
    buffer_load_dwordx4 v[28:31], v6, s[52:55], s11 offen
    s_add_u32 s11, s11, 8192
    buffer_load_dwordx4 v[32:35], v6, s[52:55], s11 offen
    s_add_u32 s11, s11, 8192
    buffer_load_dwordx4 v[36:39], v6, s[52:55], s11 offen
    s_add_u32 s11, s11, 8192
    buffer_load_dwordx4 v[40:43], v6, s[52:55], s11 offen
    s_add_u32 s11, s11, 8192
    buffer_load_dwordx4 v[44:47], v6, s[52:55], s11 offen
    s_add_u32 s11, s11, 8192
    buffer_load_dwordx4 v[48:51], v6, s[52:55], s11 offen
    s_add_u32 s11, s11, 8192
    buffer_load_dwordx4 v[52:55], v6, s[52:55], s11 offen
    s_add_u32 s11, s11, 8192
    buffer_load_dwordx4 v[56:59], v6, s[52:55], s11 offen
    s_add_u32 s11, s11, 8192
    buffer_load_dwordx4 v[60:63], v6, s[52:55], s11 offen
    s_add_u32 s11, s11, 8192
    buffer_load_dwordx4 v[64:67], v6, s[52:55], s11 offen
    s_add_u32 s11, s11, 8192
    buffer_load_dwordx4 v[68:71], v6, s[52:55], s11 offen
    s_add_u32 s11, s11, 8192
    buffer_load_dwordx4 v[72:75], v6, s[52:55], s11 offen
    s_add_u32 s11, s11, 8192
    buffer_load_dwordx4 v[76:79], v6, s[52:55], s11 offen
    s_add_u32 s11, s11, 8192
    buffer_load_dwordx4 v[80:83], v6, s[52:55], s11 offen
    s_add_u32 s11, s11, 8192
    buffer_load_dwordx4 v[84:87], v6, s[52:55], s11 offen
    s_branch L_c1
L_not0:
    s_cmp_lg_u32 s3, 7
    s_cbranch_scc1 L_nopf
    s_getpc_b64 s[8:9]
L_pc:
    v_and_b32 v4, 7, v1
    v_lshlrev_b32 v4, 6, v4
    s_lshl_b32 s10, s5, 9
    v_add_u32 v4, s10, v4
    v_min_u32 v5, L_end-L_pc, v4
    global_load_dword v232, v5, s[8:9]
L_nopf:
    s_waitcnt lgkmcnt(0)
    s_mov_b64 s[48:49], s[16:17]
    s_mov_b64 s[52:53], s[20:21]
L_c1:
    s_mov_b64 s[44:45], s[40:41]
    s_load_dword s42, s[40:41], 0
    s_cmp_ge_u32 s2, 128
    s_cbranch_scc1 L_B0
    s_mov_b64 s[56:57], s[22:23]
    s_mov_b32 s58, 0x400000
    s_mov_b64 s[60:61], s[24:25]
    s_mov_b32 s62, 0x400000
    s_lshr_b32 s8, s7, 1
    s_and_b32 s9, s7, 1
    v_xor_b32 v7, v3, v2
    v_lshlrev_b32 v7, 4, v7
    v_lshl_add_u32 v7, v2, 13, v7
    s_lshl_b32 s15, s7, 3
    s_add_u32 s15, s15, s3
    s_lshl_b32 s15, s15, 17
    s_lshl_b32 s11, s6, 8
    s_add_u32 s15, s15, s11
    s_lshl_b32 s11, s3, 13
    s_barrier
    s_cmp_lg_u32 s3, 1
    s_cbranch_scc1 L_Hnt
    v_lshlrev_b32 v4, 5, v1
    s_lshl_b32 s10, s6, 2
    s_add_u32 s10, s10, s7
    s_lshl_b32 s10, s10, 11
    s_add_u32 s10, s10, 0x10000
    buffer_load_dword v237, v4, s[44:47], s10 offen sc1
L_Hnt:
    s_mov_b32 m0, s11
    s_add_u32 s11, s11, 1024
    buffer_load_dwordx4 v7, s[56:59], s15 offen  lds
    s_add_u32 s15, s15, 0x8000
    v_xor_b32 v7, 64, v7
    s_mov_b32 m0, s11
    s_add_u32 s11, s11, 1024
    buffer_load_dwordx4 v7, s[56:59], s15 offen  lds
    s_add_u32 s15, s15, 0x8000
    v_xor_b32 v7, 192, v7
    s_mov_b32 m0, s11
    s_add_u32 s11, s11, 1024
    buffer_load_dwordx4 v7, s[56:59], s15 offen  lds
    s_add_u32 s15, s15, 0x8000
    v_xor_b32 v7, 64, v7
    s_mov_b32 m0, s11
    s_add_u32 s11, s11, 1024
    buffer_load_dwordx4 v7, s[56:59], s15 offen  lds
    s_add_u32 s15, s15, 0x8000
    s_waitcnt lgkmcnt(0)
    s_add_u32 s42, s42, 1
    s_and_b32 s43, s42, 0xff
    s_cmp_eq_u32 s3, 0
    s_cbranch_scc1 L_A1
    s_cmp_ge_u32 s3, 4
    s_cbranch_scc1 L_Hpoll1
    s_barrier
    s_waitcnt vmcnt(0)
    s_branch L_Hb2
L_B0:
    s_lshl_b32 s97, s7, 20
    s_lshl_b32 s8, s6, 8
    s_add_u32 s97, s97, s8
    s_bfe_u32 s8, s5, 0x30001
    s_lshr_b32 s6, s4, 2
    s_and_b32 s7, s4, 3
    s_lshl_b32 s7, s7, 3
    s_add_u32 s7, s7, s8
    s_and_b32 s8, s5, 1
    s_lshl_b32 s5, s8, 2
    s_xor_b32 s5, s5, s3
    s_lshl_b32 s10, s6, 5
    s_add_u32 s10, s10, s7
    s_lshl_b32 s10, s10, 3
    s_add_u32 s10, s10, s5
    s_lshl_b32 s10, s10, 14
    s_mul_i32 s9, s5, 16896
    s_mov_b32 s14, s9
    v_lshlrev_b32 v7, 4, v1
    s_mov_b64 s[60:61], s[18:19]
    s_mov_b32 s62, 0x800000
    s_mov_b64 s[56:57], s[36:37]
    s_mov_b32 s58, 2048
    s_barrier
    s_cmp_lg_u32 s3, 0
    s_cbranch_scc1 L_B1
    s_mov_b32 m0, s14
    s_add_u32 s14, s14, 1056
    buffer_load_dwordx4 v7, s[60:63], s10 offen  lds
    s_add_u32 s10, s10, 1024
    s_mov_b32 m0, s14
    s_add_u32 s14, s14, 1056
    buffer_load_dwordx4 v7, s[60:63], s10 offen  lds
    s_add_u32 s10, s10, 1024
    s_mov_b32 m0, s14
    s_add_u32 s14, s14, 1056
    buffer_load_dwordx4 v7, s[60:63], s10 offen  lds
    s_add_u32 s10, s10, 1024
    s_mov_b32 m0, s14
    s_add_u32 s14, s14, 1056
    buffer_load_dwordx4 v7, s[60:63], s10 offen  lds
    s_add_u32 s10, s10, 1024
    s_waitcnt lgkmcnt(0)
    s_add_u32 s42, s42, 1
    s_and_b32 s43, s42, 0xff
L_A1:
    v_and_b32 v128, 1, v1
    v_lshlrev_b32 v128, 4, v128
    v_mov_b32 v129, 0x0c0c0100
    v_mov_b32 v130, 0x0c0c0302
    v_alignbit_b32 v129, v129, v129, v128
    v_alignbit_b32 v130, v130, v130, v128
    v_bfe_u32 v128, v1, 1, 2
    v_mov_b32 v131, 0x0c0c0c0c
    v_cmp_eq_u32 vcc, 0, v128
    s_nop 1
    v_cndmask_b32 v248, v131, v129, vcc
    v_cndmask_b32 v249, v131, v130, vcc
    v_cmp_eq_u32 vcc, 1, v128
    s_nop 1
    v_cndmask_b32 v250, v131, v129, vcc
    v_cndmask_b32 v251, v131, v130, vcc
    v_cmp_eq_u32 vcc, 2, v128
    s_nop 1
    v_cndmask_b32 v252, v131, v129, vcc
    v_cndmask_b32 v253, v131, v130, vcc
    v_cmp_eq_u32 vcc, 3, v128
    s_nop 1
    v_cndmask_b32 v254, v131, v129, vcc
    v_cndmask_b32 v255, v131, v130, vcc
    v_lshlrev_b32 v4, 4, v1
    s_mov_b32 s15, 0xffff0000
    v_mov_b32 v131, 0x3f803f80
    v_mov_b32 v128, 0
    s_waitcnt vmcnt(22)
    v_dot2_f32_bf16 v128, v8, v131, v128
    v_dot2_f32_bf16 v128, v9, v131, v128
    v_dot2_f32_bf16 v128, v10, v131, v128
    v_dot2_f32_bf16 v128, v11, v131, v128
    v_dot2_f32_bf16 v128, v12, v131, v128
    v_dot2_f32_bf16 v128, v13, v131, v128
    v_dot2_f32_bf16 v128, v14, v131, v128
    v_dot2_f32_bf16 v128, v15, v131, v128
    v_lshlrev_b32 v112, 16, v8
    v_and_b32 v113, s15, v8
    v_lshlrev_b32 v114, 16, v9
    v_and_b32 v115, s15, v9
    v_add_f32_dpp v128, v128, v128 quad_perm:[1,0,3,2] row_mask:0xf bank_mask:0xf
    v_lshlrev_b32 v116, 16, v10
    v_and_b32 v117, s15, v10
    v_add_f32_dpp v128, v128, v128 quad_perm:[2,3,0,1] row_mask:0xf bank_mask:0xf
    v_lshlrev_b32 v118, 16, v11
    v_and_b32 v119, s15, v11
    v_add_f32_dpp v128, v128, v128 row_half_mirror row_mask:0xf bank_mask:0xf
    v_mov_b32 v129, v128
    v_lshlrev_b32 v120, 16, v12
    v_and_b32 v121, s15, v12
    v_permlane16_swap_b32 v128, v129
    v_add_f32 v128, v128, v129
    v_mov_b32 v129, v128
    v_lshlrev_b32 v122, 16, v13
    v_and_b32 v123, s15, v13
    v_permlane32_swap_b32 v128, v129
    v_add_f32 v128, v128, v129
    v_lshlrev_b32 v124, 16, v14
    v_and_b32 v125, s15, v14
    v_lshlrev_b32 v126, 16, v15
    v_and_b32 v127, s15, v15
    v_mul_f32 v128, 0xbb000000, v128
    v_mov_b32 v129, v128
    v_pk_add_f32 v[112:113], v[112:113], v[128:129]
    v_pk_add_f32 v[114:115], v[114:115], v[128:129]
    v_pk_add_f32 v[116:117], v[116:117], v[128:129]
    v_pk_add_f32 v[118:119], v[118:119], v[128:129]
    v_pk_add_f32 v[120:121], v[120:121], v[128:129]
    v_pk_add_f32 v[122:123], v[122:123], v[128:129]
    v_pk_add_f32 v[124:125], v[124:125], v[128:129]
    v_pk_add_f32 v[126:127], v[126:127], v[128:129]
    v_pk_mul_f32 v[130:131], v[112:113], v[112:113]
    v_pk_fma_f32 v[130:131], v[114:115], v[114:115], v[130:131]
    v_pk_fma_f32 v[130:131], v[116:117], v[116:117], v[130:131]
    v_pk_fma_f32 v[130:131], v[118:119], v[118:119], v[130:131]
    v_pk_fma_f32 v[130:131], v[120:121], v[120:121], v[130:131]
    v_pk_fma_f32 v[130:131], v[122:123], v[122:123], v[130:131]
    v_pk_fma_f32 v[130:131], v[124:125], v[124:125], v[130:131]
    v_pk_fma_f32 v[130:131], v[126:127], v[126:127], v[130:131]
    v_add_f32 v130, v130, v131
    s_waitcnt vmcnt(20)
    v_lshlrev_b32 v144, 16, v16
    v_and_b32 v145, s15, v16
    v_add_f32_dpp v130, v130, v130 quad_perm:[1,0,3,2] row_mask:0xf bank_mask:0xf
    v_lshlrev_b32 v146, 16, v17
    v_and_b32 v147, s15, v17
    v_add_f32_dpp v130, v130, v130 quad_perm:[2,3,0,1] row_mask:0xf bank_mask:0xf
    v_lshlrev_b32 v148, 16, v18
    v_and_b32 v149, s15, v18
    v_add_f32_dpp v130, v130, v130 row_half_mirror row_mask:0xf bank_mask:0xf
    v_mov_b32 v131, v130
    v_lshlrev_b32 v150, 16, v19
    v_and_b32 v151, s15, v19
    v_permlane16_swap_b32 v130, v131
    v_add_f32 v130, v130, v131
    v_mov_b32 v131, v130
    v_lshlrev_b32 v152, 16, v20
    v_and_b32 v153, s15, v20
    v_permlane32_swap_b32 v130, v131
    v_add_f32 v130, v130, v131
    v_mul_f32 v130, 0x3b000000, v130
    v_cvt_pk_bf16_f32 v131, v128, v130
    v_lshlrev_b32 v154, 16, v21
    v_and_b32 v155, s15, v21
    v_lshlrev_b32 v128, 16, v131
    v_and_b32 v130, s15, v131
    v_add_f32 v130, 0x3727c5ac, v130
    v_cvt_pk_bf16_f32 v130, v130, v130
    v_and_b32 v130, s15, v130
    v_sqrt_f32 v130, v130
    v_lshlrev_b32 v156, 16, v22
    v_and_b32 v157, s15, v22
    v_cvt_pk_bf16_f32 v130, v130, v130
    v_and_b32 v130, s15, v130
    v_rcp_f32 v130, v130
    v_lshlrev_b32 v158, 16, v23
    v_and_b32 v159, s15, v23
    v_mov_b32 v129, v128
    v_mov_b32 v131, v130
    v_pk_add_f32 v[144:145], v[144:145], v[128:129]
    v_cvt_pk_bf16_f32 v240, v144, v145
    v_lshlrev_b32 v144, 16, v240
    v_and_b32 v145, s15, v240
    v_pk_mul_f32 v[144:145], v[144:145], v[130:131]
    v_cvt_pk_bf16_f32 v240, v144, v145
    v_pk_add_f32 v[146:147], v[146:147], v[128:129]
    v_cvt_pk_bf16_f32 v241, v146, v147
    v_lshlrev_b32 v146, 16, v241
    v_and_b32 v147, s15, v241
    v_pk_mul_f32 v[146:147], v[146:147], v[130:131]
    v_cvt_pk_bf16_f32 v241, v146, v147
    v_pk_add_f32 v[148:149], v[148:149], v[128:129]
    v_cvt_pk_bf16_f32 v242, v148, v149
    v_lshlrev_b32 v148, 16, v242
    v_and_b32 v149, s15, v242
    v_pk_mul_f32 v[148:149], v[148:149], v[130:131]
    v_cvt_pk_bf16_f32 v242, v148, v149
    v_pk_add_f32 v[150:151], v[150:151], v[128:129]
    v_cvt_pk_bf16_f32 v243, v150, v151
    v_lshlrev_b32 v150, 16, v243
    v_and_b32 v151, s15, v243
    v_pk_mul_f32 v[150:151], v[150:151], v[130:131]
    v_cvt_pk_bf16_f32 v243, v150, v151
    v_pk_add_f32 v[152:153], v[152:153], v[128:129]
    v_cvt_pk_bf16_f32 v244, v152, v153
    v_lshlrev_b32 v152, 16, v244
    v_and_b32 v153, s15, v244
    v_pk_mul_f32 v[152:153], v[152:153], v[130:131]
    v_cvt_pk_bf16_f32 v244, v152, v153
    v_pk_add_f32 v[154:155], v[154:155], v[128:129]
    v_cvt_pk_bf16_f32 v245, v154, v155
    v_lshlrev_b32 v154, 16, v245
    v_and_b32 v155, s15, v245
    v_pk_mul_f32 v[154:155], v[154:155], v[130:131]
    v_cvt_pk_bf16_f32 v245, v154, v155
    v_pk_add_f32 v[156:157], v[156:157], v[128:129]
    v_cvt_pk_bf16_f32 v246, v156, v157
    v_lshlrev_b32 v156, 16, v246
    v_and_b32 v157, s15, v246
    v_pk_mul_f32 v[156:157], v[156:157], v[130:131]
    v_cvt_pk_bf16_f32 v246, v156, v157
    v_pk_add_f32 v[158:159], v[158:159], v[128:129]
    v_cvt_pk_bf16_f32 v247, v158, v159
    v_lshlrev_b32 v158, 16, v247
    v_and_b32 v159, s15, v247
    v_pk_mul_f32 v[158:159], v[158:159], v[130:131]
    v_cvt_pk_bf16_f32 v247, v158, v159
    v_perm_b32 v132, v240, v240, v248
    v_perm_b32 v133, v240, v240, v250
    v_perm_b32 v134, v240, v240, v252
    v_perm_b32 v135, v240, v240, v254
    v_perm_b32 v136, v240, v240, v249
    v_perm_b32 v137, v240, v240, v251
    v_perm_b32 v138, v240, v240, v253
    v_perm_b32 v139, v240, v240, v255
    s_waitcnt vmcnt(19)
    v_mfma_f32_16x16x32_bf16 v[140:143], v[132:135], v[24:27], 0
    v_perm_b32 v132, v241, v241, v248
    v_perm_b32 v133, v241, v241, v250
    v_perm_b32 v134, v241, v241, v252
    v_perm_b32 v135, v241, v241, v254
    s_waitcnt vmcnt(18)
    v_mfma_f32_16x16x32_bf16 v[140:143], v[136:139], v[28:31], v[140:143]
    v_perm_b32 v136, v241, v241, v249
    v_perm_b32 v137, v241, v241, v251
    v_perm_b32 v138, v241, v241, v253
    v_perm_b32 v139, v241, v241, v255
    s_waitcnt vmcnt(17)
    v_mfma_f32_16x16x32_bf16 v[140:143], v[132:135], v[32:35], v[140:143]
    v_perm_b32 v132, v242, v242, v248
    v_perm_b32 v133, v242, v242, v250
    v_perm_b32 v134, v242, v242, v252
    v_perm_b32 v135, v242, v242, v254
    s_waitcnt vmcnt(16)
    v_mfma_f32_16x16x32_bf16 v[140:143], v[136:139], v[36:39], v[140:143]
    v_perm_b32 v136, v242, v242, v249
    v_perm_b32 v137, v242, v242, v251
    v_perm_b32 v138, v242, v242, v253
    v_perm_b32 v139, v242, v242, v255
    s_waitcnt vmcnt(15)
    v_mfma_f32_16x16x32_bf16 v[140:143], v[132:135], v[40:43], v[140:143]
    v_perm_b32 v132, v243, v243, v248
    v_perm_b32 v133, v243, v243, v250
    v_perm_b32 v134, v243, v243, v252
    v_perm_b32 v135, v243, v243, v254
    s_waitcnt vmcnt(14)
    v_mfma_f32_16x16x32_bf16 v[140:143], v[136:139], v[44:47], v[140:143]
    v_perm_b32 v136, v243, v243, v249
    v_perm_b32 v137, v243, v243, v251
    v_perm_b32 v138, v243, v243, v253
    v_perm_b32 v139, v243, v243, v255
    s_waitcnt vmcnt(13)
    v_mfma_f32_16x16x32_bf16 v[140:143], v[132:135], v[48:51], v[140:143]
    v_perm_b32 v132, v244, v244, v248
    v_perm_b32 v133, v244, v244, v250
    v_perm_b32 v134, v244, v244, v252
    v_perm_b32 v135, v244, v244, v254
    s_waitcnt vmcnt(12)
    v_mfma_f32_16x16x32_bf16 v[140:143], v[136:139], v[52:55], v[140:143]
    v_perm_b32 v136, v244, v244, v249
    v_perm_b32 v137, v244, v244, v251
    v_perm_b32 v138, v244, v244, v253
    v_perm_b32 v139, v244, v244, v255
    s_waitcnt vmcnt(11)
    v_mfma_f32_16x16x32_bf16 v[140:143], v[132:135], v[56:59], v[140:143]
    v_perm_b32 v132, v245, v245, v248
    v_perm_b32 v133, v245, v245, v250
    v_perm_b32 v134, v245, v245, v252
    v_perm_b32 v135, v245, v245, v254
    s_waitcnt vmcnt(10)
    v_mfma_f32_16x16x32_bf16 v[140:143], v[136:139], v[60:63], v[140:143]
    v_perm_b32 v136, v245, v245, v249
    v_perm_b32 v137, v245, v245, v251
    v_perm_b32 v138, v245, v245, v253
    v_perm_b32 v139, v245, v245, v255
    s_waitcnt vmcnt(9)
    v_mfma_f32_16x16x32_bf16 v[140:143], v[132:135], v[64:67], v[140:143]
    v_perm_b32 v132, v246, v246, v248
    v_perm_b32 v133, v246, v246, v250
    v_perm_b32 v134, v246, v246, v252
    v_perm_b32 v135, v246, v246, v254
    s_waitcnt vmcnt(8)
    v_mfma_f32_16x16x32_bf16 v[140:143], v[136:139], v[68:71], v[140:143]
    v_perm_b32 v136, v246, v246, v249
    v_perm_b32 v137, v246, v246, v251
    v_perm_b32 v138, v246, v246, v253
    v_perm_b32 v139, v246, v246, v255
    s_waitcnt vmcnt(7)
    v_mfma_f32_16x16x32_bf16 v[140:143], v[132:135], v[72:75], v[140:143]
    v_perm_b32 v132, v247, v247, v248
    v_perm_b32 v133, v247, v247, v250
    v_perm_b32 v134, v247, v247, v252
    v_perm_b32 v135, v247, v247, v254
    s_waitcnt vmcnt(6)
    v_mfma_f32_16x16x32_bf16 v[140:143], v[136:139], v[76:79], v[140:143]
    v_perm_b32 v136, v247, v247, v249
    v_perm_b32 v137, v247, v247, v251
    v_perm_b32 v138, v247, v247, v253
    v_perm_b32 v139, v247, v247, v255
    s_waitcnt vmcnt(5)
    v_mfma_f32_16x16x32_bf16 v[140:143], v[132:135], v[80:83], v[140:143]
    s_waitcnt vmcnt(4)
    v_mfma_f32_16x16x32_bf16 v[140:143], v[136:139], v[84:87], v[140:143]
    s_mov_b32 s15, 0xffffff00
    v_mov_b32 v128, s43
    s_add_u32 s12, s13, 0x10000
    s_add_u32 s13, s13, 0x300000
    s_nop 3
    v_and_or_b32 v140, v140, s15, v128
    v_and_or_b32 v141, v141, s15, v128
    v_and_or_b32 v142, v142, s15, v128
    v_and_or_b32 v143, v143, s15, v128
    buffer_store_dwordx4 v[140:143], v4, s[44:47], s12 offen
    buffer_store_dwordx4 v[140:143], v4, s[44:47], s13 offen sc1
    s_barrier
    s_cmp_ge_u32 s2, 128
    s_cbranch_scc1 L_B0b
    s_bfe_u32 s97, s5, 0x10003
    s_xor_b32 s97, s97, 1
    s_lshl_b32 s97, s97, 3
    s_add_u32 s97, s97, s4
    s_mul_i32 s99, s96, 176128
    s_cmp_ge_u32 s97, 11
    s_cselect_b64 s[52:53], s[32:33], s[30:31]
    s_cselect_b32 s12, 11, 0
    s_sub_u32 s12, s97, s12
    s_lshl_b32 s12, s12, 8
    s_add_u32 s98, s99, s12
    s_add_u32 s12, s97, 5
    s_lshl_b32 s12, s12, 8
    s_add_u32 s99, s99, s12
    s_mov_b32 s54, 1409024
    s_waitcnt vmcnt(2)
    s_branch L_Hb2
L_Hpoll1:
    v_subrev_u32 v5, 256, v0
    v_lshlrev_b32 v4, 2, v5
    s_lshl_b32 s10, s6, 13
    s_add_u32 s10, s10, 0x10000
    s_add_u32 s11, s10, 4096
    v_lshrrev_b32 v6, 7, v5
    v_mul_u32_u24 v6, 320, v6
    v_bfe_u32 v12, v5, 2, 4
    v_lshl_add_u32 v6, v12, 4, v6
    v_bfe_u32 v12, v5, 6, 1
    v_lshl_add_u32 v6, v12, 3, v6
    v_and_b32 v5, 3, v5
    v_lshl_add_u32 v5, v5, 1, v6
    v_add_u32 v5, 147456, v5
    s_mov_b32 s12, 0
    s_mov_b32 s13, 0xffffff00
    s_barrier
    s_waitcnt vmcnt(0)
    buffer_load_dword v12, v4, s[44:47], s10 offen offset:0 sc1
    buffer_load_dword v13, v4, s[44:47], s10 offen offset:1024 sc1
    buffer_load_dword v14, v4, s[44:47], s10 offen offset:2048 sc1
    buffer_load_dword v15, v4, s[44:47], s10 offen offset:3072 sc1
    buffer_load_dword v16, v4, s[44:47], s11 offen offset:0 sc1
    buffer_load_dword v17, v4, s[44:47], s11 offen offset:1024 sc1
    buffer_load_dword v18, v4, s[44:47], s11 offen offset:2048 sc1
    buffer_load_dword v19, v4, s[44:47], s11 offen offset:3072 sc1
    v_xor_b32 v6, v2, v3
    v_lshlrev_b32 v6, 4, v6
    v_lshl_add_u32 v6, v3, 8, v6
    s_lshl_b32 s15, s3, 13
    v_add_u32 v6, s15, v6
    ds_read_b128 v[88:91], v6
    v_xor_b32 v6, 64, v6
    ds_read_b128 v[92:95], v6
    v_xor_b32 v6, 192, v6
    ds_read_b128 v[96:99], v6
    v_xor_b32 v6, 64, v6
    ds_read_b128 v[100:103], v6
    v_bfe_u32 v30, v3, 2, 1
    v_mul_u32_u24 v30, 320, v30
    v_lshl_add_u32 v30, v2, 4, v30
    v_add_u32 v30, 147456, v30
    v_lshlrev_b32 v31, 16, v2
    v_lshl_add_u32 v31, v3, 2, v31
    s_lshl_b32 s14, s6, 11
    s_lshl_b32 s15, s7, 9
    s_add_u32 s14, s14, s15
    s_lshl_b32 s15, s3, 6
    s_add_u32 s14, s14, s15
    s_add_u32 s14, s14, 0x80000
    s_and_b32 s15, s42, 0xffff
    v_mov_b32 v29, s15
    v_mul_u32_u24 v166, 44032, v2
    v_lshl_add_u32 v166, v3, 4, v166
L_Hpoll1l:
    s_add_u32 s12, s12, 1
    s_cmp_eq_u32 s12, 12
    s_cselect_b32 s15, 0x2f0000, 0
    s_add_u32 s10, s10, s15
    s_add_u32 s11, s11, s15
    s_waitcnt vmcnt(0)
    v_xor_b32 v20, s43, v12
    v_bitop3_b32 v20, v20, v13, s43 bitop3:0xf6
    v_bitop3_b32 v20, v20, v14, s43 bitop3:0xf6
    v_bitop3_b32 v20, v20, v15, s43 bitop3:0xf6
    v_bitop3_b32 v20, v20, v16, s43 bitop3:0xf6
    v_bitop3_b32 v20, v20, v17, s43 bitop3:0xf6
    v_bitop3_b32 v20, v20, v18, s43 bitop3:0xf6
    v_bitop3_b32 v20, v20, v19, s43 bitop3:0xf6
    v_and_b32 v20, 0xff, v20
    v_cmp_ne_u32 vcc, 0, v20
    s_cbranch_vccz L_Hpoll1d
    s_cmp_gt_u32 s12, 20000
    s_cbranch_scc1 L_Hpoll1d
    buffer_load_dword v12, v4, s[44:47], s10 offen offset:0 sc1
    buffer_load_dword v13, v4, s[44:47], s10 offen offset:1024 sc1
    buffer_load_dword v14, v4, s[44:47], s10 offen offset:2048 sc1
    buffer_load_dword v15, v4, s[44:47], s10 offen offset:3072 sc1
    buffer_load_dword v16, v4, s[44:47], s11 offen offset:0 sc1
    buffer_load_dword v17, v4, s[44:47], s11 offen offset:1024 sc1
    buffer_load_dword v18, v4, s[44:47], s11 offen offset:2048 sc1
    buffer_load_dword v19, v4, s[44:47], s11 offen offset:3072 sc1
    s_branch L_Hpoll1l
L_Hpoll1d:
    v_and_b32 v12, s13, v12
    v_and_b32 v13, s13, v13
    v_and_b32 v14, s13, v14
    v_and_b32 v15, s13, v15
    v_and_b32 v16, s13, v16
    v_and_b32 v17, s13, v17
    v_and_b32 v18, s13, v18
    v_and_b32 v19, s13, v19
    v_add_f32 v12, v12, v13
    v_add_f32 v14, v14, v15
    v_add_f32 v16, v16, v17
    v_add_f32 v18, v18, v19
    v_add_f32 v12, v12, v14
    v_add_f32 v16, v16, v18
    v_add_f32 v12, v12, v16
    v_cvt_pk_bf16_f32 v12, v12, v12
    ds_write_b16 v5, v12
    s_branch L_Hb3
L_Hb2:
    v_xor_b32 v6, v2, v3
    v_lshlrev_b32 v6, 4, v6
    v_lshl_add_u32 v6, v3, 8, v6
    s_lshl_b32 s15, s3, 13
    v_add_u32 v6, s15, v6
    ds_read_b128 v[88:91], v6
    v_xor_b32 v6, 64, v6
    ds_read_b128 v[92:95], v6
    v_xor_b32 v6, 192, v6
    ds_read_b128 v[96:99], v6
    v_xor_b32 v6, 64, v6
    ds_read_b128 v[100:103], v6
    v_bfe_u32 v30, v3, 2, 1
    v_mul_u32_u24 v30, 320, v30
    v_lshl_add_u32 v30, v2, 4, v30
    v_add_u32 v30, 147456, v30
    v_lshlrev_b32 v31, 16, v2
    v_lshl_add_u32 v31, v3, 2, v31
    s_lshl_b32 s14, s6, 11
    s_lshl_b32 s15, s7, 9
    s_add_u32 s14, s14, s15
    s_lshl_b32 s15, s3, 6
    s_add_u32 s14, s14, s15
    s_add_u32 s14, s14, 0x80000
    s_and_b32 s15, s42, 0xffff
    v_mov_b32 v29, s15
    v_mul_u32_u24 v166, 44032, v2
    v_lshl_add_u32 v166, v3, 4, v166
L_Hb3:
    s_waitcnt lgkmcnt(0)
    s_barrier
    ds_read_b128 v[8:11], v30 offset:0
    ds_read_b128 v[12:15], v30 offset:64
    ds_read_b128 v[16:19], v30 offset:128
    ds_read_b128 v[20:23], v30 offset:192
    s_mov_b32 s11, 0xffff0000
    s_waitcnt lgkmcnt(3)
    v_mfma_f32_16x16x32_bf16 v[24:27], v[8:11], v[88:91], 0
    s_waitcnt lgkmcnt(2)
    v_mfma_f32_16x16x32_bf16 v[24:27], v[12:15], v[92:95], v[24:27]
    s_waitcnt lgkmcnt(1)
    v_mfma_f32_16x16x32_bf16 v[24:27], v[16:19], v[96:99], v[24:27]
    s_waitcnt lgkmcnt(0)
    v_mfma_f32_16x16x32_bf16 v[24:27], v[20:23], v[100:103], v[24:27]
    s_mov_b32 exec_lo, 0xffffffff
    s_mov_b32 exec_hi, 0x0
    s_nop 5
    v_cvt_pk_bf16_f32 v28, v24, v24
    v_and_or_b32 v28, v28, s11, v29
    buffer_store_dword v28, v31, s[44:47], s14 offen sc1
    s_mov_b64 exec, -1
    s_cmp_lg_u32 s3, 0
    s_cbranch_scc1 L_Hng
    buffer_load_dwordx4 v[32:35], v166, s[52:55], s98 offen
    s_add_u32 s98, s98, 2752
    buffer_load_dwordx4 v[36:39], v166, s[52:55], s98 offen
    s_add_u32 s98, s98, 2752
    buffer_load_dwordx4 v[40:43], v166, s[52:55], s98 offen
    s_add_u32 s98, s98, 2752
    buffer_load_dwordx4 v[44:47], v166, s[52:55], s98 offen
    s_add_u32 s98, s98, 2752
    buffer_load_dwordx4 v[48:51], v166, s[52:55], s98 offen
    s_add_u32 s98, s98, 2752
    buffer_load_dwordx4 v[52:55], v166, s[52:55], s98 offen
    s_add_u32 s98, s98, 2752
    buffer_load_dwordx4 v[56:59], v166, s[52:55], s98 offen
    s_add_u32 s98, s98, 2752
    buffer_load_dwordx4 v[60:63], v166, s[52:55], s98 offen
    s_add_u32 s98, s98, 2752
    buffer_load_dwordx4 v[64:67], v166, s[52:55], s98 offen
    s_add_u32 s98, s98, 2752
    buffer_load_dwordx4 v[68:71], v166, s[52:55], s98 offen
    s_add_u32 s98, s98, 2752
    buffer_load_dwordx4 v[72:75], v166, s[52:55], s98 offen
    s_add_u32 s98, s98, 2752
    buffer_load_dwordx4 v[76:79], v166, s[52:55], s98 offen
    s_add_u32 s98, s98, 2752
    buffer_load_dwordx4 v[80:83], v166, s[52:55], s98 offen
    s_add_u32 s98, s98, 2752
    buffer_load_dwordx4 v[84:87], v166, s[52:55], s98 offen
    s_add_u32 s98, s98, 2752
    buffer_load_dwordx4 v[88:91], v166, s[52:55], s98 offen
    s_add_u32 s98, s98, 2752
    buffer_load_dwordx4 v[92:95], v166, s[52:55], s98 offen
    s_cmp_ge_u32 s97, 6
    s_cbranch_scc1 L_Hng
    s_mov_b64 s[52:53], s[32:33]
    buffer_load_dwordx4 v[168:171], v166, s[52:55], s99 offen
    s_add_u32 s99, s99, 2752
    buffer_load_dwordx4 v[172:175], v166, s[52:55], s99 offen
    s_add_u32 s99, s99, 2752
    buffer_load_dwordx4 v[176:179], v166, s[52:55], s99 offen
    s_add_u32 s99, s99, 2752
    buffer_load_dwordx4 v[180:183], v166, s[52:55], s99 offen
    s_add_u32 s99, s99, 2752
    buffer_load_dwordx4 v[184:187], v166, s[52:55], s99 offen
    s_add_u32 s99, s99, 2752
    buffer_load_dwordx4 v[188:191], v166, s[52:55], s99 offen
    s_add_u32 s99, s99, 2752
    buffer_load_dwordx4 v[192:195], v166, s[52:55], s99 offen
    s_add_u32 s99, s99, 2752
    buffer_load_dwordx4 v[196:199], v166, s[52:55], s99 offen
    s_add_u32 s99, s99, 2752
    buffer_load_dwordx4 v[200:203], v166, s[52:55], s99 offen
    s_add_u32 s99, s99, 2752
    buffer_load_dwordx4 v[204:207], v166, s[52:55], s99 offen
    s_add_u32 s99, s99, 2752
    buffer_load_dwordx4 v[208:211], v166, s[52:55], s99 offen
    s_add_u32 s99, s99, 2752
    buffer_load_dwordx4 v[212:215], v166, s[52:55], s99 offen
    s_add_u32 s99, s99, 2752
    buffer_load_dwordx4 v[216:219], v166, s[52:55], s99 offen
    s_add_u32 s99, s99, 2752
    buffer_load_dwordx4 v[220:223], v166, s[52:55], s99 offen
    s_add_u32 s99, s99, 2752
    buffer_load_dwordx4 v[224:227], v166, s[52:55], s99 offen
    s_add_u32 s99, s99, 2752
    buffer_load_dwordx4 v[228:231], v166, s[52:55], s99 offen
L_Hng:
    s_barrier
    s_cmp_lg_u32 s3, 0
    s_cbranch_scc1 L_Hg2
    s_lshl_b32 s12, s97, 3
    s_add_u32 s12, s12, s96
    s_lshl_b32 s12, s12, 10
    s_add_u32 s12, s12, 0x50000
    s_add_u32 s13, s12, 131072
    s_mov_b32 s15, 0xffffff00
    v_mov_b32 v16, s43
    v_lshlrev_b32 v5, 4, v1
    v_perm_b32 v104, v240, v240, v248
    v_perm_b32 v105, v240, v240, v250
    v_perm_b32 v106, v240, v240, v252
    v_perm_b32 v107, v240, v240, v254
    s_waitcnt vmcnt(0)
    v_perm_b32 v108, v240, v240, v249
    v_perm_b32 v109, v240, v240, v251
    v_perm_b32 v110, v240, v240, v253
    v_perm_b32 v111, v240, v240, v255
    v_mfma_f32_16x16x32_bf16 v[112:115], v[104:107], v[32:35], 0
    v_mfma_f32_16x16x32_bf16 v[116:119], v[104:107], v[168:171], 0
    v_perm_b32 v104, v241, v241, v248
    v_perm_b32 v105, v241, v241, v250
    v_perm_b32 v106, v241, v241, v252
    v_perm_b32 v107, v241, v241, v254
    v_mfma_f32_16x16x32_bf16 v[112:115], v[108:111], v[36:39], v[112:115]
    v_mfma_f32_16x16x32_bf16 v[116:119], v[108:111], v[172:175], v[116:119]
    v_perm_b32 v108, v241, v241, v249
    v_perm_b32 v109, v241, v241, v251
    v_perm_b32 v110, v241, v241, v253
    v_perm_b32 v111, v241, v241, v255
    v_mfma_f32_16x16x32_bf16 v[112:115], v[104:107], v[40:43], v[112:115]
    v_mfma_f32_16x16x32_bf16 v[116:119], v[104:107], v[176:179], v[116:119]
    v_perm_b32 v104, v242, v242, v248
    v_perm_b32 v105, v242, v242, v250
    v_perm_b32 v106, v242, v242, v252
    v_perm_b32 v107, v242, v242, v254
    v_mfma_f32_16x16x32_bf16 v[112:115], v[108:111], v[44:47], v[112:115]
    v_mfma_f32_16x16x32_bf16 v[116:119], v[108:111], v[180:183], v[116:119]
    v_perm_b32 v108, v242, v242, v249
    v_perm_b32 v109, v242, v242, v251
    v_perm_b32 v110, v242, v242, v253
    v_perm_b32 v111, v242, v242, v255
    v_mfma_f32_16x16x32_bf16 v[112:115], v[104:107], v[48:51], v[112:115]
    v_mfma_f32_16x16x32_bf16 v[116:119], v[104:107], v[184:187], v[116:119]
    v_perm_b32 v104, v243, v243, v248
    v_perm_b32 v105, v243, v243, v250
    v_perm_b32 v106, v243, v243, v252
    v_perm_b32 v107, v243, v243, v254
    v_mfma_f32_16x16x32_bf16 v[112:115], v[108:111], v[52:55], v[112:115]
    v_mfma_f32_16x16x32_bf16 v[116:119], v[108:111], v[188:191], v[116:119]
    v_perm_b32 v108, v243, v243, v249
    v_perm_b32 v109, v243, v243, v251
    v_perm_b32 v110, v243, v243, v253
    v_perm_b32 v111, v243, v243, v255
    v_mfma_f32_16x16x32_bf16 v[112:115], v[104:107], v[56:59], v[112:115]
    v_mfma_f32_16x16x32_bf16 v[116:119], v[104:107], v[192:195], v[116:119]
    v_perm_b32 v104, v244, v244, v248
    v_perm_b32 v105, v244, v244, v250
    v_perm_b32 v106, v244, v244, v252
    v_perm_b32 v107, v244, v244, v254
    v_mfma_f32_16x16x32_bf16 v[112:115], v[108:111], v[60:63], v[112:115]
    v_mfma_f32_16x16x32_bf16 v[116:119], v[108:111], v[196:199], v[116:119]
    v_perm_b32 v108, v244, v244, v249
    v_perm_b32 v109, v244, v244, v251
    v_perm_b32 v110, v244, v244, v253
    v_perm_b32 v111, v244, v244, v255
    v_mfma_f32_16x16x32_bf16 v[112:115], v[104:107], v[64:67], v[112:115]
    v_mfma_f32_16x16x32_bf16 v[116:119], v[104:107], v[200:203], v[116:119]
    v_perm_b32 v104, v245, v245, v248
    v_perm_b32 v105, v245, v245, v250
    v_perm_b32 v106, v245, v245, v252
    v_perm_b32 v107, v245, v245, v254
    v_mfma_f32_16x16x32_bf16 v[112:115], v[108:111], v[68:71], v[112:115]
    v_mfma_f32_16x16x32_bf16 v[116:119], v[108:111], v[204:207], v[116:119]
    v_perm_b32 v108, v245, v245, v249
    v_perm_b32 v109, v245, v245, v251
    v_perm_b32 v110, v245, v245, v253
    v_perm_b32 v111, v245, v245, v255
    v_mfma_f32_16x16x32_bf16 v[112:115], v[104:107], v[72:75], v[112:115]
    v_mfma_f32_16x16x32_bf16 v[116:119], v[104:107], v[208:211], v[116:119]
    v_perm_b32 v104, v246, v246, v248
    v_perm_b32 v105, v246, v246, v250
    v_perm_b32 v106, v246, v246, v252
    v_perm_b32 v107, v246, v246, v254
    v_mfma_f32_16x16x32_bf16 v[112:115], v[108:111], v[76:79], v[112:115]
    v_mfma_f32_16x16x32_bf16 v[116:119], v[108:111], v[212:215], v[116:119]
    v_perm_b32 v108, v246, v246, v249
    v_perm_b32 v109, v246, v246, v251
    v_perm_b32 v110, v246, v246, v253
    v_perm_b32 v111, v246, v246, v255
    v_mfma_f32_16x16x32_bf16 v[112:115], v[104:107], v[80:83], v[112:115]
    v_mfma_f32_16x16x32_bf16 v[116:119], v[104:107], v[216:219], v[116:119]
    v_perm_b32 v104, v247, v247, v248
    v_perm_b32 v105, v247, v247, v250
    v_perm_b32 v106, v247, v247, v252
    v_perm_b32 v107, v247, v247, v254
    v_mfma_f32_16x16x32_bf16 v[112:115], v[108:111], v[84:87], v[112:115]
    v_mfma_f32_16x16x32_bf16 v[116:119], v[108:111], v[220:223], v[116:119]
    v_perm_b32 v108, v247, v247, v249
    v_perm_b32 v109, v247, v247, v251
    v_perm_b32 v110, v247, v247, v253
    v_perm_b32 v111, v247, v247, v255
    v_mfma_f32_16x16x32_bf16 v[112:115], v[104:107], v[88:91], v[112:115]
    v_mfma_f32_16x16x32_bf16 v[116:119], v[104:107], v[224:227], v[116:119]
    v_mfma_f32_16x16x32_bf16 v[112:115], v[108:111], v[92:95], v[112:115]
    v_mfma_f32_16x16x32_bf16 v[116:119], v[108:111], v[228:231], v[116:119]
    s_nop 6
    v_and_or_b32 v112, v112, s15, v16
    v_and_or_b32 v113, v113, s15, v16
    v_and_or_b32 v114, v114, s15, v16
    v_and_or_b32 v115, v115, s15, v16
    v_and_or_b32 v116, v116, s15, v16
    v_and_or_b32 v117, v117, s15, v16
    v_and_or_b32 v118, v118, s15, v16
    v_and_or_b32 v119, v119, s15, v16
    buffer_store_dwordx4 v[112:115], v5, s[44:47], s12 offen sc1
    s_cmp_ge_u32 s97, 6
    s_cbranch_scc1 L_Hg1
    buffer_store_dwordx4 v[116:119], v5, s[44:47], s13 offen sc1
L_Hg1:
L_Hg2:
    s_lshl_b32 s14, s6, 1
    s_add_u32 s14, s14, s8
    s_and_b32 s98, s3, 3
    s_cmp_eq_u32 s98, 0
    s_cselect_b32 s98, 4, 0
    s_xor_b32 s98, s98, s3
    s_cmp_lt_u32 s98, 4
    s_cbranch_scc1 L_Hc0
    s_barrier
L_Hc0:
    s_mov_b64 s[56:57], s[26:27]
    s_lshr_b32 s12, s98, 2
    s_and_b32 s13, s98, 1
    s_bitcmp1_b32 s98, 1
    s_cbranch_scc1 L_Hwo
    s_xor_b32 s12, s12, s9
    s_lshl_b32 s12, s12, 1
    s_add_u32 s13, s13, s12
    v_and_b32 v164, 1, v2
    v_lshlrev_b32 v164, 1, v164
    v_xor_b32 v164, v164, v3
    v_lshlrev_b32 v165, 13, v2
    v_lshl_add_u32 v164, v164, 4, v165
    s_lshl_b32 s10, s8, 2
    s_add_u32 s10, s10, s13
    s_lshl_b32 s10, s10, 19
    s_lshl_b32 s11, s6, 8
    s_add_u32 s10, s10, s11
    s_lshl_b32 s11, s13, 14
    s_add_u32 s11, s11, 0
    s_mov_b32 m0, s11
    s_add_u32 s11, s11, 1024
    buffer_load_dwordx4 v164, s[60:63], s10 offen  lds
    s_add_u32 s10, s10, 0x8000
    s_mov_b32 m0, s11
    s_add_u32 s11, s11, 1024
    buffer_load_dwordx4 v164, s[60:63], s10 offen  lds
    s_add_u32 s10, s10, 0x8000
    s_mov_b32 m0, s11
    s_add_u32 s11, s11, 1024
    buffer_load_dwordx4 v164, s[60:63], s10 offen  lds
    s_add_u32 s10, s10, 0x8000
    s_mov_b32 m0, s11
    s_add_u32 s11, s11, 1024
    buffer_load_dwordx4 v164, s[60:63], s10 offen  lds
    s_add_u32 s10, s10, 0x8000
    v_xor_b32 v164, 64, v164
    s_mov_b32 m0, s11
    s_add_u32 s11, s11, 1024
    buffer_load_dwordx4 v164, s[60:63], s10 offen  lds
    s_add_u32 s10, s10, 0x8000
    s_mov_b32 m0, s11
    s_add_u32 s11, s11, 1024
    buffer_load_dwordx4 v164, s[60:63], s10 offen  lds
    s_add_u32 s10, s10, 0x8000
    s_mov_b32 m0, s11
    s_add_u32 s11, s11, 1024
    buffer_load_dwordx4 v164, s[60:63], s10 offen  lds
    s_add_u32 s10, s10, 0x8000
    s_mov_b32 m0, s11
    s_add_u32 s11, s11, 1024
    buffer_load_dwordx4 v164, s[60:63], s10 offen  lds
    s_add_u32 s10, s10, 0x8000
    v_xor_b32 v164, 192, v164
    s_mov_b32 m0, s11
    s_add_u32 s11, s11, 1024
    buffer_load_dwordx4 v164, s[60:63], s10 offen  lds
    s_add_u32 s10, s10, 0x8000
    s_mov_b32 m0, s11
    s_add_u32 s11, s11, 1024
    buffer_load_dwordx4 v164, s[60:63], s10 offen  lds
    s_add_u32 s10, s10, 0x8000
    s_mov_b32 m0, s11
    s_add_u32 s11, s11, 1024
    buffer_load_dwordx4 v164, s[60:63], s10 offen  lds
    s_add_u32 s10, s10, 0x8000
    s_mov_b32 m0, s11
    s_add_u32 s11, s11, 1024
    buffer_load_dwordx4 v164, s[60:63], s10 offen  lds
    s_add_u32 s10, s10, 0x8000
    v_xor_b32 v164, 64, v164
    s_mov_b32 m0, s11
    s_add_u32 s11, s11, 1024
    buffer_load_dwordx4 v164, s[60:63], s10 offen  lds
    s_add_u32 s10, s10, 0x8000
    s_mov_b32 m0, s11
    s_add_u32 s11, s11, 1024
    buffer_load_dwordx4 v164, s[60:63], s10 offen  lds
    s_add_u32 s10, s10, 0x8000
    s_mov_b32 m0, s11
    s_add_u32 s11, s11, 1024
    buffer_load_dwordx4 v164, s[60:63], s10 offen  lds
    s_add_u32 s10, s10, 0x8000
    s_mov_b32 m0, s11
    s_add_u32 s11, s11, 1024
    buffer_load_dwordx4 v164, s[60:63], s10 offen  lds
    s_add_u32 s10, s10, 0x8000
    s_branch L_Hprep
L_Hwo:
    s_xor_b32 s12, s12, s8
    s_lshl_b32 s12, s12, 1
    s_add_u32 s13, s13, s12
    v_lshrrev_b32 v164, 5, v1
    v_and_b32 v165, 31, v1
    v_lshlrev_b32 v160, 1, v164
    v_xor_b32 v165, v165, v160
    v_lshlrev_b32 v164, 10, v164
    v_lshl_add_u32 v160, v165, 4, v164
    v_xor_b32 v161, 0x40, v160
    v_xor_b32 v162, 0x80, v160
    v_xor_b32 v163, 0xc0, v160
    s_lshl_b32 s10, s6, 2
    s_add_u32 s10, s10, s13
    s_lshl_b32 s10, s10, 15
    s_lshl_b32 s11, s9, 9
    s_add_u32 s10, s10, s11
    s_lshl_b32 s11, s13, 14
    s_add_u32 s11, s11, 65536
    s_mov_b32 m0, s11
    s_add_u32 s11, s11, 1024
    buffer_load_dwordx4 v160, s[56:59], s10 offen  lds
    s_add_u32 s10, s10, 2048
    s_mov_b32 m0, s11
    s_add_u32 s11, s11, 1024
    buffer_load_dwordx4 v161, s[56:59], s10 offen  lds
    s_add_u32 s10, s10, 2048
    s_mov_b32 m0, s11
    s_add_u32 s11, s11, 1024
    buffer_load_dwordx4 v162, s[56:59], s10 offen  lds
    s_add_u32 s10, s10, 2048
    s_mov_b32 m0, s11
    s_add_u32 s11, s11, 1024
    buffer_load_dwordx4 v163, s[56:59], s10 offen  lds
    s_add_u32 s10, s10, 2048
    s_mov_b32 m0, s11
    s_add_u32 s11, s11, 1024
    buffer_load_dwordx4 v160, s[56:59], s10 offen  lds
    s_add_u32 s10, s10, 2048
    s_mov_b32 m0, s11
    s_add_u32 s11, s11, 1024
    buffer_load_dwordx4 v161, s[56:59], s10 offen  lds
    s_add_u32 s10, s10, 2048
    s_mov_b32 m0, s11
    s_add_u32 s11, s11, 1024
    buffer_load_dwordx4 v162, s[56:59], s10 offen  lds
    s_add_u32 s10, s10, 2048
    s_mov_b32 m0, s11
    s_add_u32 s11, s11, 1024
    buffer_load_dwordx4 v163, s[56:59], s10 offen  lds
    s_add_u32 s10, s10, 2048
    s_mov_b32 m0, s11
    s_add_u32 s11, s11, 1024
    buffer_load_dwordx4 v160, s[56:59], s10 offen  lds
    s_add_u32 s10, s10, 2048
    s_mov_b32 m0, s11
    s_add_u32 s11, s11, 1024
    buffer_load_dwordx4 v161, s[56:59], s10 offen  lds
    s_add_u32 s10, s10, 2048
    s_mov_b32 m0, s11
    s_add_u32 s11, s11, 1024
    buffer_load_dwordx4 v162, s[56:59], s10 offen  lds
    s_add_u32 s10, s10, 2048
    s_mov_b32 m0, s11
    s_add_u32 s11, s11, 1024
    buffer_load_dwordx4 v163, s[56:59], s10 offen  lds
    s_add_u32 s10, s10, 2048
    s_mov_b32 m0, s11
    s_add_u32 s11, s11, 1024
    buffer_load_dwordx4 v160, s[56:59], s10 offen  lds
    s_add_u32 s10, s10, 2048
    s_mov_b32 m0, s11
    s_add_u32 s11, s11, 1024
    buffer_load_dwordx4 v161, s[56:59], s10 offen  lds
    s_add_u32 s10, s10, 2048
    s_mov_b32 m0, s11
    s_add_u32 s11, s11, 1024
    buffer_load_dwordx4 v162, s[56:59], s10 offen  lds
    s_add_u32 s10, s10, 2048
    s_mov_b32 m0, s11
    s_add_u32 s11, s11, 1024
    buffer_load_dwordx4 v163, s[56:59], s10 offen  lds
    s_add_u32 s10, s10, 2048
L_Hprep:
    s_cmp_ge_u32 s98, 4
    s_cbranch_scc1 L_Hprep2
    s_barrier
L_Hprep2:
    v_bfe_u32 v4, v1, 2, 2
    v_and_b32 v6, 3, v1
    v_and_b32 v5, 1, v2
    v_lshl_add_u32 v5, v4, 1, v5
    v_xor_b32 v150, s3, v5
    v_lshlrev_b32 v150, 5, v150
    v_lshl_add_u32 v150, v4, 12, v150
    v_lshl_add_u32 v150, v2, 8, v150
    v_lshl_add_u32 v150, v6, 3, v150
    v_lshrrev_b32 v4, 2, v1
    v_and_b32 v5, 7, v4
    s_lshl_b32 s10, s3, 1
    v_xor_b32 v151, s10, v5
    v_lshlrev_b32 v151, 5, v151
    v_lshl_add_u32 v151, v4, 9, v151
    v_lshl_add_u32 v151, v6, 3, v151
    v_add_u32 v151, 65536, v151
    v_xor_b32 v152, 32, v151
    v_lshlrev_b32 v4, 11, v2
    v_lshl_add_u32 v4, v3, 4, v4
    s_lshl_b32 s10, s14, 15
    s_bfe_u32 s11, s3, 0x10001
    s_lshl_b32 s12, s11, 14
    s_add_u32 s10, s10, s12
    s_lshr_b32 s12, s3, 2
    s_lshl_b32 s13, s12, 13
    s_add_u32 s10, s10, s13
    s_and_b32 s13, s3, 1
    s_lshl_b32 s15, s13, 8
    s_add_u32 s10, s10, s15
    s_add_u32 s10, s10, 0x100000
    s_lshl_b32 s15, s11, 1
    s_add_u32 s15, s15, s12
    s_lshl_b32 s15, s15, 6
    s_add_u32 s15, s15, 148096
    v_lshl_add_u32 v5, v2, 4, s15
    s_lshl_b32 s15, s11, 2
    s_add_u32 s15, s15, 148352
    v_mov_b32 v6, s15
    s_lshl_b32 s15, s12, 1
    s_add_u32 s15, s15, s11
    s_mul_i32 s15, s15, 576
    s_lshl_b32 s13, s13, 8
    s_add_u32 s15, s15, s13
    s_add_u32 s15, s15, 148480
    v_lshlrev_b32 v7, 4, v3
    v_lshl_add_u32 v7, v2, 3, v7
    v_add_u32 v7, s15, v7
    v_and_b32 v12, 1, v3
    v_lshlrev_b32 v12, 4, v12
    v_mov_b32 v13, 0xffff
    v_lshlrev_b32 v12, v12, v13
    v_lshrrev_b32 v13, 1, v3
    v_cmp_eq_u32 vcc, 0, v13
    s_nop 1
    v_cndmask_b32 v8, 0, v12, vcc
    v_cmp_eq_u32 vcc, 1, v13
    s_nop 1
    v_cndmask_b32 v9, 0, v12, vcc
    v_cmp_eq_u32 vcc, 2, v13
    s_nop 1
    v_cndmask_b32 v10, 0, v12, vcc
    v_cmp_eq_u32 vcc, 3, v13
    s_nop 1
    v_cndmask_b32 v11, 0, v12, vcc
    v_and_b32 v12, 3, v3
    v_mul_u32_u24 v12, 576, v12
    v_lshl_add_u32 v12, v2, 4, v12
    v_add_u32 v12, 148480, v12
    v_and_b32 v13, 1, v3
    v_mul_u32_u24 v13, 320, v13
    v_lshl_add_u32 v13, v2, 4, v13
    s_lshr_b32 s15, s3, 1
    s_lshl_b32 s15, s15, 6
    s_and_b32 s13, s3, 1
    s_lshl_b32 s13, s13, 3
    s_add_u32 s15, s15, s13
    s_add_u32 s15, s15, 150784
    v_add_u32 v13, s15, v13
    v_bfe_u32 v14, v3, 2, 1
    v_mul_u32_u24 v14, 320, v14
    v_lshl_add_u32 v14, v2, 4, v14
    v_add_u32 v14, 150784, v14
    v_mul_u32_u24 v15, 229376, v2
    v_lshl_add_u32 v15, v3, 3, v15
    s_lshl_b32 s11, s9, 3
    s_add_u32 s11, s11, s3
    s_mul_i32 s11, s11, 14336
    s_lshl_b32 s13, s14, 7
    s_add_u32 s11, s11, s13
    s_add_u32 s11, s11, 0x340000
    s_waitcnt vmcnt(0)
    s_barrier
    s_cmp_eq_u32 s3, 0
    s_cbranch_scc0 L_Hb4
    v_lshlrev_b32 v16, 9, v1
    s_lshr_b32 s13, s6, 4
    s_lshl_b32 s13, s13, 8
    s_and_b32 s15, s6, 15
    s_lshl_b32 s15, s15, 4
    s_add_u32 s13, s13, s15
    s_add_u32 s13, s13, 0xa0000
    s_mov_b32 s15, 0
    buffer_load_dwordx4 v[20:23], v16, s[44:47], s13 offen sc1
L_Hb4:
    ds_read_b64_tr_b16 v[32:33], v150 offset:0
    ds_read_b64_tr_b16 v[34:35], v150 offset:2048
    ds_read_b64_tr_b16 v[36:37], v150 offset:1024
    ds_read_b64_tr_b16 v[38:39], v150 offset:3072
    ds_read_b64_tr_b16 v[40:41], v150 offset:16384
    ds_read_b64_tr_b16 v[42:43], v150 offset:18432
    ds_read_b64_tr_b16 v[44:45], v150 offset:17408
    ds_read_b64_tr_b16 v[46:47], v150 offset:19456
    ds_read_b64_tr_b16 v[48:49], v150 offset:32768
    ds_read_b64_tr_b16 v[50:51], v150 offset:34816
    ds_read_b64_tr_b16 v[52:53], v150 offset:33792
    ds_read_b64_tr_b16 v[54:55], v150 offset:35840
    ds_read_b64_tr_b16 v[56:57], v150 offset:49152
    ds_read_b64_tr_b16 v[58:59], v150 offset:51200
    ds_read_b64_tr_b16 v[60:61], v150 offset:50176
    ds_read_b64_tr_b16 v[62:63], v150 offset:52224
    ds_read_b64_tr_b16 v[64:65], v151 offset:0
    ds_read_b64_tr_b16 v[66:67], v151 offset:8192
    ds_read_b64_tr_b16 v[68:69], v151 offset:16384
    ds_read_b64_tr_b16 v[70:71], v151 offset:24576
    ds_read_b64_tr_b16 v[72:73], v151 offset:32768
    ds_read_b64_tr_b16 v[74:75], v151 offset:40960
    ds_read_b64_tr_b16 v[76:77], v151 offset:49152
    ds_read_b64_tr_b16 v[78:79], v151 offset:57344
    ds_read_b64_tr_b16 v[80:81], v152 offset:0
    ds_read_b64_tr_b16 v[82:83], v152 offset:8192
    ds_read_b64_tr_b16 v[84:85], v152 offset:16384
    ds_read_b64_tr_b16 v[86:87], v152 offset:24576
    ds_read_b64_tr_b16 v[88:89], v152 offset:32768
    ds_read_b64_tr_b16 v[90:91], v152 offset:40960
    ds_read_b64_tr_b16 v[92:93], v152 offset:49152
    ds_read_b64_tr_b16 v[94:95], v152 offset:57344
    s_cmp_eq_u32 s3, 0
    s_cbranch_scc0 L_Hb4b
L_HpollS:
    s_add_u32 s15, s15, 1
    s_waitcnt vmcnt(0)
    v_xor_b32 v17, s42, v21
    v_bitop3_b32 v17, v17, v23, s42 bitop3:0xf6
    v_cmp_ne_u32 vcc, 0, v17
    s_cbranch_vccz L_HpollSd
    s_cmp_gt_u32 s15, 20000
    s_cbranch_scc1 L_HpollSd
    buffer_load_dwordx4 v[20:23], v16, s[44:47], s13 offen sc1
    s_branch L_HpollS
L_HpollSd:
L_Hb4b:
    s_barrier
    buffer_load_dwordx4 v[116:119], v4, s[44:47], s10 offen offset:0 sc1
    buffer_load_dwordx4 v[120:123], v4, s[44:47], s10 offen offset:512 sc1
    buffer_load_dwordx4 v[124:127], v4, s[44:47], s10 offen offset:1024 sc1
    buffer_load_dwordx4 v[128:131], v4, s[44:47], s10 offen offset:1536 sc1
    s_cmp_eq_u32 s3, 0
    s_cbranch_scc0 L_Hb5
    v_mov_b32 v17, v20
    s_nop 1
    v_max_f32_dpp v17, v17, v17 quad_perm:[1,0,3,2] row_mask:0xf bank_mask:0xf
    s_nop 1
    v_max_f32_dpp v17, v17, v17 quad_perm:[2,3,0,1] row_mask:0xf bank_mask:0xf
    s_nop 1
    v_max_f32_dpp v17, v17, v17 row_half_mirror row_mask:0xf bank_mask:0xf
    s_nop 1
    v_max_f32_dpp v17, v17, v17 row_mirror row_mask:0xf bank_mask:0xf
    v_mov_b32 v18, v17
    s_nop 1
    v_permlane16_swap_b32 v17, v18
    v_max_f32 v17, v17, v18
    v_sub_f32 v17, v20, v17
    v_exp_f32 v17, v17
    s_nop 0
    v_cvt_pk_bf16_f32 v17, v17, v17
    v_and_b32 v18, 0xffff0000, v17
    v_mul_f32 v18, v18, v22
    v_lshlrev_b32 v19, 2, v1
    v_add_u32 v19, 148096, v19
    ds_write_b32 v19, v17
    v_add_f32_dpp v18, v18, v18 quad_perm:[1,0,3,2] row_mask:0xf bank_mask:0xf
    s_nop 1
    v_add_f32_dpp v18, v18, v18 quad_perm:[2,3,0,1] row_mask:0xf bank_mask:0xf
    s_nop 1
    v_add_f32_dpp v18, v18, v18 row_half_mirror row_mask:0xf bank_mask:0xf
    s_nop 1
    v_add_f32_dpp v18, v18, v18 row_mirror row_mask:0xf bank_mask:0xf
    v_mov_b32 v17, v18
    s_nop 1
    v_permlane16_swap_b32 v18, v17
    v_add_f32 v18, v18, v17
    v_rcp_f32 v18, v18
    v_lshrrev_b32 v19, 5, v1
    v_lshlrev_b32 v19, 2, v19
    v_add_u32 v19, 148352, v19
    ds_write_b32 v19, v18
    s_waitcnt lgkmcnt(0)
L_Hb5:
    s_barrier
    ds_read_b128 v[16:19], v5
    ds_read_b32 v20, v6
    s_waitcnt lgkmcnt(0)
    v_and_b32 v132, v16, v8
    v_and_b32 v133, v16, v9
    v_and_b32 v134, v16, v10
    v_and_b32 v135, v16, v11
    v_and_b32 v136, v17, v8
    v_and_b32 v137, v17, v9
    v_and_b32 v138, v17, v10
    v_and_b32 v139, v17, v11
    v_and_b32 v140, v18, v8
    v_and_b32 v141, v18, v9
    v_and_b32 v142, v18, v10
    v_and_b32 v143, v18, v11
    v_and_b32 v144, v19, v8
    v_and_b32 v145, v19, v9
    v_and_b32 v146, v19, v10
    v_and_b32 v147, v19, v11
    s_mov_b32 s15, 0
L_HpollP:
    s_waitcnt vmcnt(0)
    v_max3_u32 v21, v116, v117, v118
    v_max3_u32 v21, v21, v119, v120
    v_max3_u32 v21, v21, v121, v122
    v_max3_u32 v21, v21, v123, v124
    v_max3_u32 v21, v21, v125, v126
    v_max3_u32 v21, v21, v127, v128
    v_max3_u32 v21, v21, v129, v130
    v_max_u32 v21, v21, v131
    v_cmp_eq_u32 vcc, -1, v21
    s_cbranch_vccz L_HpollPd
    s_add_u32 s15, s15, 1
    s_cmp_gt_u32 s15, 20000
    s_cbranch_scc1 L_HpollPd
    buffer_load_dwordx4 v[116:119], v4, s[44:47], s10 offen offset:0 sc1
    buffer_load_dwordx4 v[120:123], v4, s[44:47], s10 offen offset:512 sc1
    buffer_load_dwordx4 v[124:127], v4, s[44:47], s10 offen offset:1024 sc1
    buffer_load_dwordx4 v[128:131], v4, s[44:47], s10 offen offset:1536 sc1
    s_branch L_HpollP
L_HpollPd:
    v_mfma_f32_16x16x32_bf16 v[24:27], v[132:135], v[116:119], 0
    v_mfma_f32_16x16x32_bf16 v[24:27], v[136:139], v[120:123], v[24:27]
    v_mfma_f32_16x16x32_bf16 v[24:27], v[140:143], v[124:127], v[24:27]
    v_mfma_f32_16x16x32_bf16 v[24:27], v[144:147], v[128:131], v[24:27]
    s_mov_b32 exec_lo, 0xffffffff
    s_mov_b32 exec_hi, 0x0
    s_nop 5
    v_mul_f32 v24, v24, v20
    v_mul_f32 v25, v25, v20
    v_mul_f32 v26, v26, v20
    v_mul_f32 v27, v27, v20
    v_cvt_pk_bf16_f32 v24, v24, v25
    v_cvt_pk_bf16_f32 v25, v26, v27
    ds_write_b64 v7, v[24:25]
    s_mov_b64 exec, -1
    s_waitcnt lgkmcnt(0)
    s_barrier
    ds_read_b128 v[116:119], v12 offset:0
    ds_read_b128 v[120:123], v12 offset:64
    ds_read_b128 v[124:127], v12 offset:128
    ds_read_b128 v[128:131], v12 offset:192
    ds_read_b128 v[132:135], v12 offset:256
    ds_read_b128 v[136:139], v12 offset:320
    ds_read_b128 v[140:143], v12 offset:384
    ds_read_b128 v[144:147], v12 offset:448
    s_waitcnt lgkmcnt(7)
    v_mfma_f32_16x16x32_bf16 v[28:31], v[32:35], v[116:119], 0
    s_waitcnt lgkmcnt(6)
    v_mfma_f32_16x16x32_bf16 v[28:31], v[36:39], v[120:123], v[28:31]
    s_waitcnt lgkmcnt(5)
    v_mfma_f32_16x16x32_bf16 v[28:31], v[40:43], v[124:127], v[28:31]
    s_waitcnt lgkmcnt(4)
    v_mfma_f32_16x16x32_bf16 v[28:31], v[44:47], v[128:131], v[28:31]
    s_waitcnt lgkmcnt(3)
    v_mfma_f32_16x16x32_bf16 v[28:31], v[48:51], v[132:135], v[28:31]
    s_waitcnt lgkmcnt(2)
    v_mfma_f32_16x16x32_bf16 v[28:31], v[52:55], v[136:139], v[28:31]
    s_waitcnt lgkmcnt(1)
    v_mfma_f32_16x16x32_bf16 v[28:31], v[56:59], v[140:143], v[28:31]
    s_waitcnt lgkmcnt(0)
    v_mfma_f32_16x16x32_bf16 v[28:31], v[60:63], v[144:147], v[28:31]
    s_nop 7
    v_add_f32_dpp v28, v28, v28 quad_perm:[2,3,0,1] row_mask:0xf bank_mask:0xf
    v_add_f32_dpp v29, v29, v29 quad_perm:[2,3,0,1] row_mask:0xf bank_mask:0xf
    v_add_f32_dpp v30, v30, v30 quad_perm:[2,3,0,1] row_mask:0xf bank_mask:0xf
    v_add_f32_dpp v31, v31, v31 quad_perm:[2,3,0,1] row_mask:0xf bank_mask:0xf
    s_mov_b32 exec_lo, 0x30003
    s_mov_b32 exec_hi, 0x30003
    v_cvt_pk_bf16_f32 v28, v28, v29
    v_cvt_pk_bf16_f32 v29, v30, v31
    ds_write_b64 v13, v[28:29]
    s_mov_b64 exec, -1
    s_waitcnt lgkmcnt(0)
    s_barrier
    ds_read_b128 v[116:119], v14 offset:0
    ds_read_b128 v[120:123], v14 offset:64
    ds_read_b128 v[124:127], v14 offset:128
    ds_read_b128 v[128:131], v14 offset:192
    s_mov_b32 s15, 0xffffff00
    v_mov_b32 v16, s43
    s_waitcnt lgkmcnt(3)
    v_mfma_f32_16x16x32_bf16 v[104:107], v[116:119], v[64:67], 0
    v_mfma_f32_16x16x32_bf16 v[108:111], v[116:119], v[80:83], 0
    s_waitcnt lgkmcnt(2)
    v_mfma_f32_16x16x32_bf16 v[104:107], v[120:123], v[68:71], v[104:107]
    v_mfma_f32_16x16x32_bf16 v[108:111], v[120:123], v[84:87], v[108:111]
    s_waitcnt lgkmcnt(1)
    v_mfma_f32_16x16x32_bf16 v[104:107], v[124:127], v[72:75], v[104:107]
    v_mfma_f32_16x16x32_bf16 v[108:111], v[124:127], v[88:91], v[108:111]
    s_waitcnt lgkmcnt(0)
    v_mfma_f32_16x16x32_bf16 v[104:107], v[128:131], v[76:79], v[104:107]
    v_mfma_f32_16x16x32_bf16 v[108:111], v[128:131], v[92:95], v[108:111]
    s_mov_b32 exec_lo, 0xffffffff
    s_mov_b32 exec_hi, 0x0
    s_nop 4
    v_and_or_b32 v18, v104, s15, v16
    v_and_or_b32 v19, v108, s15, v16
    buffer_store_dwordx2 v[18:19], v15, s[44:47], s11 offen sc1
    s_mov_b64 exec, -1
    s_branch L_fin
L_B0b:
    s_mov_b32 m0, s14
    s_add_u32 s14, s14, 1056
    buffer_load_dwordx4 v7, s[60:63], s10 offen  lds
    s_add_u32 s10, s10, 1024
    s_mov_b32 m0, s14
    s_add_u32 s14, s14, 1056
    buffer_load_dwordx4 v7, s[60:63], s10 offen  lds
    s_add_u32 s10, s10, 1024
    s_mov_b32 m0, s14
    s_add_u32 s14, s14, 1056
    buffer_load_dwordx4 v7, s[60:63], s10 offen  lds
    s_add_u32 s10, s10, 1024
    s_mov_b32 m0, s14
    s_add_u32 s14, s14, 1056
    buffer_load_dwordx4 v7, s[60:63], s10 offen  lds
    s_add_u32 s10, s10, 1024
    s_mov_b32 m0, s14
    s_add_u32 s14, s14, 1056
    buffer_load_dwordx4 v7, s[60:63], s10 offen  lds
    s_add_u32 s10, s10, 1024
    s_mov_b32 m0, s14
    s_add_u32 s14, s14, 1056
    buffer_load_dwordx4 v7, s[60:63], s10 offen  lds
    s_add_u32 s10, s10, 1024
    s_mov_b32 m0, s14
    s_add_u32 s14, s14, 1056
    buffer_load_dwordx4 v7, s[60:63], s10 offen  lds
    s_add_u32 s10, s10, 1024
    s_mov_b32 m0, s14
    s_add_u32 s14, s14, 1056
    buffer_load_dwordx4 v7, s[60:63], s10 offen  lds
    s_add_u32 s10, s10, 1024
    s_mov_b32 m0, s14
    s_add_u32 s14, s14, 1056
    buffer_load_dwordx4 v7, s[60:63], s10 offen  lds
    s_add_u32 s10, s10, 1024
    s_mov_b32 m0, s14
    s_add_u32 s14, s14, 1056
    buffer_load_dwordx4 v7, s[60:63], s10 offen  lds
    s_add_u32 s10, s10, 1024
    s_mov_b32 m0, s14
    s_add_u32 s14, s14, 1056
    buffer_load_dwordx4 v7, s[60:63], s10 offen  lds
    s_add_u32 s10, s10, 1024
    s_mov_b32 m0, s14
    s_add_u32 s14, s14, 1056
    buffer_load_dwordx4 v7, s[60:63], s10 offen  lds
    s_add_u32 s10, s10, 1024
    s_barrier
    v_lshlrev_b32 v4, 4, v1
    v_and_b32 v10, 255, v0
    v_lshlrev_b32 v5, 4, v10
    s_lshl_b32 s12, s6, 1
    s_add_u32 s12, s12, s8
    s_lshl_b32 s12, s12, 15
    s_add_u32 s12, s12, 0x80000
    v_mul_u32_u24 v25, 1056, v3
    v_lshl_add_u32 v25, v2, 4, v25
    v_add_u32 v6, s9, v25
    v_add_u32 v25, 135168, v25
    v_lshrrev_b32 v8, 2, v1
    v_mul_u32_u24 v8, 1056, v8
    v_and_b32 v9, 3, v1
    v_lshl_add_u32 v8, v9, 3, v8
    s_lshl_b32 s9, s5, 7
    v_add_u32 v8, s9, v8
    s_mul_i32 s9, s8, 67584
    s_sub_u32 s11, 67584, s9
    v_add_u32 v9, s11, v8
    v_add_u32 v8, s9, v8
    v_bfe_u32 v10, v0, 7, 1
    v_mul_u32_u24 v10, 1056, v10
    v_and_b32 v11, 127, v0
    v_lshl_add_u32 v10, v11, 3, v10
    v_add_u32 v10, 135168, v10
    v_lshlrev_b32 v28, 5, v3
    v_add_u32 v28, 156160, v28
    s_lshl_b32 s9, s3, 2
    v_add_u32 v11, s9, v28
    v_add_u32 v30, 152064, v4
    s_lshr_b32 s9, s3, 1
    s_lshl_b32 s9, s9, 10
    s_and_b32 s11, s3, 1
    s_lshl_b32 s11, s11, 3
    s_add_u32 s9, s9, s11
    v_add_u32 v29, s9, v30
    v_lshrrev_b32 v31, 3, v3
    v_lshl_add_u32 v31, v2, 2, v31
    v_lshlrev_b32 v31, 16, v31
    v_and_b32 v16, 7, v3
    v_lshl_add_u32 v31, v16, 4, v31
    s_lshl_b32 s98, s8, 20
    s_lshr_b32 s9, s5, 2
    s_lshl_b32 s9, s9, 15
    s_add_u32 s98, s98, s9
    s_lshl_b32 s9, s6, 14
    s_add_u32 s98, s98, s9
    s_lshl_b32 s9, s7, 9
    s_add_u32 s98, s98, s9
    s_and_b32 s9, s5, 3
    s_lshl_b32 s9, s9, 7
    s_add_u32 s98, s98, s9
    s_add_u32 s98, s98, 0x100000
    s_add_u32 s99, s98, 0x20000
    s_lshl_b32 s11, s6, 5
    s_add_u32 s11, s11, s7
    s_lshl_b32 s11, s11, 1
    s_add_u32 s11, s11, s8
    s_lshl_b32 s11, s11, 8
    s_add_u32 s11, s11, 0xa0000
    v_lshrrev_b32 v26, 5, v1
    v_and_b32 v27, 31, v1
    v_lshlrev_b32 v16, 1, v26
    v_xor_b32 v27, v27, v16
    v_lshlrev_b32 v26, 10, v26
    v_lshl_add_u32 v26, v27, 4, v26
    s_and_b32 s9, s3, 1
    s_lshl_b32 s9, s9, 7
    v_xor_b32 v26, s9, v26
    v_xor_b32 v27, 0x40, v26
    s_sub_u32 s15, s2, 170
    s_lshr_b32 s97, s15, 1
    s_lshl_b32 s97, s97, 3
    s_add_u32 s97, s97, s3
    s_lshl_b32 s97, s97, 12
    s_and_b32 s9, s15, 1
    s_lshl_b32 s9, s9, 9
    s_add_u32 s97, s97, s9
    s_mov_b64 s[52:53], s[34:35]
    s_mov_b32 s54, 1409024
    v_mov_b32 v12, -1
    v_mov_b32 v13, -1
    v_mov_b32 v14, -1
    v_mov_b32 v15, -1
    v_mov_b32 v17, 0x07060302
    s_branch L_B2
L_B1:
    s_cmp_lt_u32 s3, 4
    s_cbranch_scc1 L_Bnuk
    s_mov_b64 s[52:53], s[22:23]
    s_lshl_b32 s11, s3, 17
    s_add_u32 s11, s11, s97
    v_lshrrev_b32 v8, 2, v1
    v_lshlrev_b32 v8, 13, v8
    v_and_b32 v9, 3, v1
    v_lshl_add_u32 v8, v9, 6, v8
    buffer_load_dword v236, v8, s[52:55], s11 offen
L_Bnuk:
    s_waitcnt lgkmcnt(0)
    s_add_u32 s42, s42, 1
    s_and_b32 s43, s42, 0xff
    v_lshlrev_b32 v4, 4, v1
    v_and_b32 v10, 255, v0
    v_lshlrev_b32 v5, 4, v10
    s_lshl_b32 s12, s6, 1
    s_add_u32 s12, s12, s8
    s_lshl_b32 s12, s12, 15
    s_add_u32 s12, s12, 0x80000
    v_mul_u32_u24 v25, 1056, v3
    v_lshl_add_u32 v25, v2, 4, v25
    v_add_u32 v6, s9, v25
    v_add_u32 v25, 135168, v25
    v_lshrrev_b32 v8, 2, v1
    v_mul_u32_u24 v8, 1056, v8
    v_and_b32 v9, 3, v1
    v_lshl_add_u32 v8, v9, 3, v8
    s_lshl_b32 s9, s5, 7
    v_add_u32 v8, s9, v8
    s_mul_i32 s9, s8, 67584
    s_sub_u32 s11, 67584, s9
    v_add_u32 v9, s11, v8
    v_add_u32 v8, s9, v8
    v_bfe_u32 v10, v0, 7, 1
    v_mul_u32_u24 v10, 1056, v10
    v_and_b32 v11, 127, v0
    v_lshl_add_u32 v10, v11, 3, v10
    v_add_u32 v10, 135168, v10
    v_lshlrev_b32 v28, 5, v3
    v_add_u32 v28, 156160, v28
    s_lshl_b32 s9, s3, 2
    v_add_u32 v11, s9, v28
    v_add_u32 v30, 152064, v4
    s_lshr_b32 s9, s3, 1
    s_lshl_b32 s9, s9, 10
    s_and_b32 s11, s3, 1
    s_lshl_b32 s11, s11, 3
    s_add_u32 s9, s9, s11
    v_add_u32 v29, s9, v30
    v_lshrrev_b32 v31, 3, v3
    v_lshl_add_u32 v31, v2, 2, v31
    v_lshlrev_b32 v31, 16, v31
    v_and_b32 v16, 7, v3
    v_lshl_add_u32 v31, v16, 4, v31
    s_lshl_b32 s98, s8, 20
    s_lshr_b32 s9, s5, 2
    s_lshl_b32 s9, s9, 15
    s_add_u32 s98, s98, s9
    s_lshl_b32 s9, s6, 14
    s_add_u32 s98, s98, s9
    s_lshl_b32 s9, s7, 9
    s_add_u32 s98, s98, s9
    s_and_b32 s9, s5, 3
    s_lshl_b32 s9, s9, 7
    s_add_u32 s98, s98, s9
    s_add_u32 s98, s98, 0x100000
    s_add_u32 s99, s98, 0x20000
    s_lshl_b32 s11, s6, 5
    s_add_u32 s11, s11, s7
    s_lshl_b32 s11, s11, 1
    s_add_u32 s11, s11, s8
    s_lshl_b32 s11, s11, 8
    s_add_u32 s11, s11, 0xa0000
    v_lshrrev_b32 v26, 5, v1
    v_and_b32 v27, 31, v1
    v_lshlrev_b32 v16, 1, v26
    v_xor_b32 v27, v27, v16
    v_lshlrev_b32 v26, 10, v26
    v_lshl_add_u32 v26, v27, 4, v26
    s_and_b32 s9, s3, 1
    s_lshl_b32 s9, s9, 7
    v_xor_b32 v26, s9, v26
    v_xor_b32 v27, 0x40, v26
    s_sub_u32 s15, s2, 170
    s_lshr_b32 s97, s15, 1
    s_lshl_b32 s97, s97, 3
    s_add_u32 s97, s97, s3
    s_lshl_b32 s97, s97, 12
    s_and_b32 s9, s15, 1
    s_lshl_b32 s9, s9, 9
    s_add_u32 s97, s97, s9
    s_mov_b64 s[52:53], s[34:35]
    s_mov_b32 s54, 1409024
    v_mov_b32 v12, -1
    v_mov_b32 v13, -1
    v_mov_b32 v14, -1
    v_mov_b32 v15, -1
    v_mov_b32 v17, 0x07060302
    s_cmp_ge_u32 s3, 4
    s_cbranch_scc1 L_B1w
    s_cmp_le_u32 s3, 0
    s_cbranch_scc1 L_B1b
    s_barrier
L_B1b:
    s_mov_b32 m0, s14
    s_add_u32 s14, s14, 1056
    buffer_load_dwordx4 v7, s[60:63], s10 offen  lds
    s_add_u32 s10, s10, 1024
    s_mov_b32 m0, s14
    s_add_u32 s14, s14, 1056
    buffer_load_dwordx4 v7, s[60:63], s10 offen  lds
    s_add_u32 s10, s10, 1024
    s_mov_b32 m0, s14
    s_add_u32 s14, s14, 1056
    buffer_load_dwordx4 v7, s[60:63], s10 offen  lds
    s_add_u32 s10, s10, 1024
    s_mov_b32 m0, s14
    s_add_u32 s14, s14, 1056
    buffer_load_dwordx4 v7, s[60:63], s10 offen  lds
    s_add_u32 s10, s10, 1024
    s_mov_b32 m0, s14
    s_add_u32 s14, s14, 1056
    buffer_load_dwordx4 v7, s[60:63], s10 offen  lds
    s_add_u32 s10, s10, 1024
    s_mov_b32 m0, s14
    s_add_u32 s14, s14, 1056
    buffer_load_dwordx4 v7, s[60:63], s10 offen  lds
    s_add_u32 s10, s10, 1024
    s_mov_b32 m0, s14
    s_add_u32 s14, s14, 1056
    buffer_load_dwordx4 v7, s[60:63], s10 offen  lds
    s_add_u32 s10, s10, 1024
    s_mov_b32 m0, s14
    s_add_u32 s14, s14, 1056
    buffer_load_dwordx4 v7, s[60:63], s10 offen  lds
    s_add_u32 s10, s10, 1024
    s_mov_b32 m0, s14
    s_add_u32 s14, s14, 1056
    buffer_load_dwordx4 v7, s[60:63], s10 offen  lds
    s_add_u32 s10, s10, 1024
    s_mov_b32 m0, s14
    s_add_u32 s14, s14, 1056
    buffer_load_dwordx4 v7, s[60:63], s10 offen  lds
    s_add_u32 s10, s10, 1024
    s_mov_b32 m0, s14
    s_add_u32 s14, s14, 1056
    buffer_load_dwordx4 v7, s[60:63], s10 offen  lds
    s_add_u32 s10, s10, 1024
    s_mov_b32 m0, s14
    s_add_u32 s14, s14, 1056
    buffer_load_dwordx4 v7, s[60:63], s10 offen  lds
    s_add_u32 s10, s10, 1024
    s_mov_b32 m0, s14
    s_add_u32 s14, s14, 1056
    buffer_load_dwordx4 v7, s[60:63], s10 offen  lds
    s_add_u32 s10, s10, 1024
    s_mov_b32 m0, s14
    s_add_u32 s14, s14, 1056
    buffer_load_dwordx4 v7, s[60:63], s10 offen  lds
    s_add_u32 s10, s10, 1024
    s_mov_b32 m0, s14
    s_add_u32 s14, s14, 1056
    buffer_load_dwordx4 v7, s[60:63], s10 offen  lds
    s_add_u32 s10, s10, 1024
    s_mov_b32 m0, s14
    s_add_u32 s14, s14, 1056
    buffer_load_dwordx4 v7, s[60:63], s10 offen  lds
    s_add_u32 s10, s10, 1024
    s_cmp_le_u32 s3, 0
    s_cbranch_scc0 L_B1c
    s_barrier
L_B1c:
    s_barrier
L_B2:
    s_barrier
    s_mov_b32 s13, s12
    buffer_load_dwordx4 v[176:179], v5, s[44:47], s13 offen sc1
    s_add_u32 s13, s13, 4096
    buffer_load_dwordx4 v[180:183], v5, s[44:47], s13 offen sc1
    s_add_u32 s13, s13, 4096
    buffer_load_dwordx4 v[184:187], v5, s[44:47], s13 offen sc1
    s_add_u32 s13, s13, 4096
    buffer_load_dwordx4 v[188:191], v5, s[44:47], s13 offen sc1
    s_add_u32 s13, s13, 4096
    buffer_load_dwordx4 v[192:195], v5, s[44:47], s13 offen sc1
    s_add_u32 s13, s13, 4096
    buffer_load_dwordx4 v[196:199], v5, s[44:47], s13 offen sc1
    s_add_u32 s13, s13, 4096
    buffer_load_dwordx4 v[200:203], v5, s[44:47], s13 offen sc1
    s_add_u32 s13, s13, 4096
    buffer_load_dwordx4 v[204:207], v5, s[44:47], s13 offen sc1
    s_waitcnt vmcnt(8)
    ds_read_b128 v[32:35], v6 offset:0
    ds_read_b128 v[36:39], v6 offset:64
    ds_read_b128 v[40:43], v6 offset:128
    ds_read_b128 v[44:47], v6 offset:192
    ds_read_b128 v[48:51], v6 offset:256
    ds_read_b128 v[52:55], v6 offset:320
    ds_read_b128 v[56:59], v6 offset:384
    ds_read_b128 v[60:63], v6 offset:448
    ds_read_b128 v[64:67], v6 offset:512
    ds_read_b128 v[68:71], v6 offset:576
    ds_read_b128 v[72:75], v6 offset:640
    ds_read_b128 v[76:79], v6 offset:704
    ds_read_b128 v[80:83], v6 offset:768
    ds_read_b128 v[84:87], v6 offset:832
    ds_read_b128 v[88:91], v6 offset:896
    ds_read_b128 v[92:95], v6 offset:960
    s_barrier
    ds_read_b64_tr_b16 v[96:97], v8 offset:0
    ds_read_b64_tr_b16 v[98:99], v8 offset:16896
    ds_read_b64_tr_b16 v[112:113], v8 offset:32
    ds_read_b64_tr_b16 v[114:115], v8 offset:16928
    ds_read_b64_tr_b16 v[128:129], v8 offset:64
    ds_read_b64_tr_b16 v[130:131], v8 offset:16960
    ds_read_b64_tr_b16 v[144:145], v8 offset:96
    ds_read_b64_tr_b16 v[146:147], v8 offset:16992
    ds_read_b64_tr_b16 v[100:101], v8 offset:33792
    ds_read_b64_tr_b16 v[102:103], v8 offset:50688
    ds_read_b64_tr_b16 v[116:117], v8 offset:33824
    ds_read_b64_tr_b16 v[118:119], v8 offset:50720
    ds_read_b64_tr_b16 v[132:133], v8 offset:33856
    ds_read_b64_tr_b16 v[134:135], v8 offset:50752
    ds_read_b64_tr_b16 v[148:149], v8 offset:33888
    ds_read_b64_tr_b16 v[150:151], v8 offset:50784
    s_mov_b32 s9, 0
L_Bpoll:
    s_waitcnt vmcnt(7)
    v_xor_b32 v16, s42, v176
    v_bitop3_b32 v16, v16, v177, s42 bitop3:0xf6
    v_bitop3_b32 v16, v16, v178, s42 bitop3:0xf6
    v_bitop3_b32 v16, v16, v179, s42 bitop3:0xf6
    s_waitcnt vmcnt(6)
    v_bitop3_b32 v16, v16, v180, s42 bitop3:0xf6
    v_bitop3_b32 v16, v16, v181, s42 bitop3:0xf6
    v_bitop3_b32 v16, v16, v182, s42 bitop3:0xf6
    v_bitop3_b32 v16, v16, v183, s42 bitop3:0xf6
    s_waitcnt vmcnt(5)
    v_bitop3_b32 v16, v16, v184, s42 bitop3:0xf6
    v_bitop3_b32 v16, v16, v185, s42 bitop3:0xf6
    v_bitop3_b32 v16, v16, v186, s42 bitop3:0xf6
    v_bitop3_b32 v16, v16, v187, s42 bitop3:0xf6
    s_waitcnt vmcnt(4)
    v_bitop3_b32 v16, v16, v188, s42 bitop3:0xf6
    v_bitop3_b32 v16, v16, v189, s42 bitop3:0xf6
    v_bitop3_b32 v16, v16, v190, s42 bitop3:0xf6
    v_bitop3_b32 v16, v16, v191, s42 bitop3:0xf6
    s_waitcnt vmcnt(3)
    v_bitop3_b32 v16, v16, v192, s42 bitop3:0xf6
    v_bitop3_b32 v16, v16, v193, s42 bitop3:0xf6
    v_bitop3_b32 v16, v16, v194, s42 bitop3:0xf6
    v_bitop3_b32 v16, v16, v195, s42 bitop3:0xf6
    s_waitcnt vmcnt(2)
    v_bitop3_b32 v16, v16, v196, s42 bitop3:0xf6
    v_bitop3_b32 v16, v16, v197, s42 bitop3:0xf6
    v_bitop3_b32 v16, v16, v198, s42 bitop3:0xf6
    v_bitop3_b32 v16, v16, v199, s42 bitop3:0xf6
    s_waitcnt vmcnt(1)
    v_bitop3_b32 v16, v16, v200, s42 bitop3:0xf6
    v_bitop3_b32 v16, v16, v201, s42 bitop3:0xf6
    v_bitop3_b32 v16, v16, v202, s42 bitop3:0xf6
    v_bitop3_b32 v16, v16, v203, s42 bitop3:0xf6
    s_waitcnt vmcnt(0)
    v_bitop3_b32 v16, v16, v204, s42 bitop3:0xf6
    v_bitop3_b32 v16, v16, v205, s42 bitop3:0xf6
    v_bitop3_b32 v16, v16, v206, s42 bitop3:0xf6
    v_bitop3_b32 v16, v16, v207, s42 bitop3:0xf6
    v_and_b32 v16, 0xffff, v16
    v_cmp_ne_u32 vcc, 0, v16
    s_cbranch_vccz L_Bpolld
    s_add_u32 s9, s9, 1
    s_cmp_gt_u32 s9, 20000
    s_cbranch_scc1 L_Bpolld
    s_mov_b32 s13, s12
    buffer_load_dwordx4 v[176:179], v5, s[44:47], s13 offen sc1
    s_add_u32 s13, s13, 4096
    buffer_load_dwordx4 v[180:183], v5, s[44:47], s13 offen sc1
    s_add_u32 s13, s13, 4096
    buffer_load_dwordx4 v[184:187], v5, s[44:47], s13 offen sc1
    s_add_u32 s13, s13, 4096
    buffer_load_dwordx4 v[188:191], v5, s[44:47], s13 offen sc1
    s_add_u32 s13, s13, 4096
    buffer_load_dwordx4 v[192:195], v5, s[44:47], s13 offen sc1
    s_add_u32 s13, s13, 4096
    buffer_load_dwordx4 v[196:199], v5, s[44:47], s13 offen sc1
    s_add_u32 s13, s13, 4096
    buffer_load_dwordx4 v[200:203], v5, s[44:47], s13 offen sc1
    s_add_u32 s13, s13, 4096
    buffer_load_dwordx4 v[204:207], v5, s[44:47], s13 offen sc1
    s_branch L_Bpoll
L_Bpolld:
    v_perm_b32 v176, v177, v176, v17
    v_perm_b32 v177, v179, v178, v17
    ds_write_b64 v10, v[176:177] offset:0
    v_perm_b32 v180, v181, v180, v17
    v_perm_b32 v181, v183, v182, v17
    ds_write_b64 v10, v[180:181] offset:2112
    v_perm_b32 v184, v185, v184, v17
    v_perm_b32 v185, v187, v186, v17
    ds_write_b64 v10, v[184:185] offset:4224
    v_perm_b32 v188, v189, v188, v17
    v_perm_b32 v189, v191, v190, v17
    ds_write_b64 v10, v[188:189] offset:6336
    v_perm_b32 v192, v193, v192, v17
    v_perm_b32 v193, v195, v194, v17
    ds_write_b64 v10, v[192:193] offset:8448
    v_perm_b32 v196, v197, v196, v17
    v_perm_b32 v197, v199, v198, v17
    ds_write_b64 v10, v[196:197] offset:10560
    v_perm_b32 v200, v201, v200, v17
    v_perm_b32 v201, v203, v202, v17
    ds_write_b64 v10, v[200:201] offset:12672
    v_perm_b32 v204, v205, v204, v17
    v_perm_b32 v205, v207, v206, v17
    ds_write_b64 v10, v[204:205] offset:14784
    s_waitcnt lgkmcnt(0)
    s_barrier
    s_branch L_B5
L_B1w:
    s_barrier
    s_barrier
    s_cmp_lt_u32 s3, 6
    s_cbranch_scc1 L_B1x
    s_barrier
L_B1x:
    s_mov_b32 m0, s14
    s_add_u32 s14, s14, 1056
    buffer_load_dwordx4 v7, s[60:63], s10 offen  lds
    s_add_u32 s10, s10, 1024
    s_mov_b32 m0, s14
    s_add_u32 s14, s14, 1056
    buffer_load_dwordx4 v7, s[60:63], s10 offen  lds
    s_add_u32 s10, s10, 1024
    s_mov_b32 m0, s14
    s_add_u32 s14, s14, 1056
    buffer_load_dwordx4 v7, s[60:63], s10 offen  lds
    s_add_u32 s10, s10, 1024
    s_mov_b32 m0, s14
    s_add_u32 s14, s14, 1056
    buffer_load_dwordx4 v7, s[60:63], s10 offen  lds
    s_add_u32 s10, s10, 1024
    s_mov_b32 m0, s14
    s_add_u32 s14, s14, 1056
    buffer_load_dwordx4 v7, s[60:63], s10 offen  lds
    s_add_u32 s10, s10, 1024
    s_mov_b32 m0, s14
    s_add_u32 s14, s14, 1056
    buffer_load_dwordx4 v7, s[60:63], s10 offen  lds
    s_add_u32 s10, s10, 1024
    s_mov_b32 m0, s14
    s_add_u32 s14, s14, 1056
    buffer_load_dwordx4 v7, s[60:63], s10 offen  lds
    s_add_u32 s10, s10, 1024
    s_mov_b32 m0, s14
    s_add_u32 s14, s14, 1056
    buffer_load_dwordx4 v7, s[60:63], s10 offen  lds
    s_add_u32 s10, s10, 1024
    s_mov_b32 m0, s14
    s_add_u32 s14, s14, 1056
    buffer_load_dwordx4 v7, s[60:63], s10 offen  lds
    s_add_u32 s10, s10, 1024
    s_mov_b32 m0, s14
    s_add_u32 s14, s14, 1056
    buffer_load_dwordx4 v7, s[60:63], s10 offen  lds
    s_add_u32 s10, s10, 1024
    s_mov_b32 m0, s14
    s_add_u32 s14, s14, 1056
    buffer_load_dwordx4 v7, s[60:63], s10 offen  lds
    s_add_u32 s10, s10, 1024
    s_mov_b32 m0, s14
    s_add_u32 s14, s14, 1056
    buffer_load_dwordx4 v7, s[60:63], s10 offen  lds
    s_add_u32 s10, s10, 1024
    s_mov_b32 m0, s14
    s_add_u32 s14, s14, 1056
    buffer_load_dwordx4 v7, s[60:63], s10 offen  lds
    s_add_u32 s10, s10, 1024
    s_mov_b32 m0, s14
    s_add_u32 s14, s14, 1056
    buffer_load_dwordx4 v7, s[60:63], s10 offen  lds
    s_add_u32 s10, s10, 1024
    s_mov_b32 m0, s14
    s_add_u32 s14, s14, 1056
    buffer_load_dwordx4 v7, s[60:63], s10 offen  lds
    s_add_u32 s10, s10, 1024
    s_mov_b32 m0, s14
    s_add_u32 s14, s14, 1056
    buffer_load_dwordx4 v7, s[60:63], s10 offen  lds
    s_add_u32 s10, s10, 1024
    s_cmp_lt_u32 s3, 6
    s_cbranch_scc0 L_B1y
    s_barrier
L_B1y:
    s_barrier
    ds_read_b64_tr_b16 v[96:97], v8 offset:0
    ds_read_b64_tr_b16 v[98:99], v8 offset:16896
    ds_read_b64_tr_b16 v[112:113], v8 offset:32
    ds_read_b64_tr_b16 v[114:115], v8 offset:16928
    ds_read_b64_tr_b16 v[128:129], v8 offset:64
    ds_read_b64_tr_b16 v[130:131], v8 offset:16960
    ds_read_b64_tr_b16 v[144:145], v8 offset:96
    ds_read_b64_tr_b16 v[146:147], v8 offset:16992
    ds_read_b64_tr_b16 v[100:101], v8 offset:33792
    ds_read_b64_tr_b16 v[102:103], v8 offset:50688
    ds_read_b64_tr_b16 v[116:117], v8 offset:33824
    ds_read_b64_tr_b16 v[118:119], v8 offset:50720
    ds_read_b64_tr_b16 v[132:133], v8 offset:33856
    ds_read_b64_tr_b16 v[134:135], v8 offset:50752
    ds_read_b64_tr_b16 v[148:149], v8 offset:33888
    ds_read_b64_tr_b16 v[150:151], v8 offset:50784
    s_waitcnt vmcnt(0)
    ds_read_b128 v[32:35], v6 offset:0
    ds_read_b128 v[36:39], v6 offset:64
    ds_read_b128 v[40:43], v6 offset:128
    ds_read_b128 v[44:47], v6 offset:192
    ds_read_b128 v[48:51], v6 offset:256
    ds_read_b128 v[52:55], v6 offset:320
    ds_read_b128 v[56:59], v6 offset:384
    ds_read_b128 v[60:63], v6 offset:448
    ds_read_b128 v[64:67], v6 offset:512
    ds_read_b128 v[68:71], v6 offset:576
    ds_read_b128 v[72:75], v6 offset:640
    ds_read_b128 v[76:79], v6 offset:704
    ds_read_b128 v[80:83], v6 offset:768
    ds_read_b128 v[84:87], v6 offset:832
    ds_read_b128 v[88:91], v6 offset:896
    ds_read_b128 v[92:95], v6 offset:960
    s_waitcnt lgkmcnt(0)
    s_barrier
L_B5:
    buffer_store_dwordx4 v[12:15], v31, s[44:47], s98 offen sc1
    buffer_store_dwordx4 v[12:15], v31, s[44:47], s99 offen sc1
    ds_read_b128 v[176:179], v25 offset:0
    ds_read_b128 v[180:183], v25 offset:64
    ds_read_b128 v[184:187], v25 offset:128
    ds_read_b128 v[188:191], v25 offset:192
    ds_read_b128 v[192:195], v25 offset:256
    ds_read_b128 v[196:199], v25 offset:320
    ds_read_b128 v[200:203], v25 offset:384
    ds_read_b128 v[204:207], v25 offset:448
    ds_read_b128 v[208:211], v25 offset:512
    ds_read_b128 v[212:215], v25 offset:576
    ds_read_b128 v[216:219], v25 offset:640
    ds_read_b128 v[220:223], v25 offset:704
    ds_read_b128 v[224:227], v25 offset:768
    ds_read_b128 v[228:231], v25 offset:832
    ds_read_b128 v[232:235], v25 offset:896
    s_waitcnt lgkmcnt(14)
    v_mfma_f32_16x16x32_bf16 v[16:19], v[32:35], v[176:179], 0
    ds_read_b128 v[236:239], v25 offset:960
    s_waitcnt lgkmcnt(14)
    v_mfma_f32_16x16x32_bf16 v[16:19], v[36:39], v[180:183], v[16:19]
    s_waitcnt lgkmcnt(13)
    v_mfma_f32_16x16x32_bf16 v[16:19], v[40:43], v[184:187], v[16:19]
    s_waitcnt lgkmcnt(12)
    v_mfma_f32_16x16x32_bf16 v[16:19], v[44:47], v[188:191], v[16:19]
    s_waitcnt lgkmcnt(11)
    v_mfma_f32_16x16x32_bf16 v[16:19], v[48:51], v[192:195], v[16:19]
    s_waitcnt lgkmcnt(10)
    v_mfma_f32_16x16x32_bf16 v[16:19], v[52:55], v[196:199], v[16:19]
    s_waitcnt lgkmcnt(9)
    v_mfma_f32_16x16x32_bf16 v[16:19], v[56:59], v[200:203], v[16:19]
    s_waitcnt lgkmcnt(8)
    v_mfma_f32_16x16x32_bf16 v[16:19], v[60:63], v[204:207], v[16:19]
    s_waitcnt lgkmcnt(7)
    v_mfma_f32_16x16x32_bf16 v[16:19], v[64:67], v[208:211], v[16:19]
    s_waitcnt lgkmcnt(6)
    v_mfma_f32_16x16x32_bf16 v[16:19], v[68:71], v[212:215], v[16:19]
    s_waitcnt lgkmcnt(5)
    v_mfma_f32_16x16x32_bf16 v[16:19], v[72:75], v[216:219], v[16:19]
    s_waitcnt lgkmcnt(4)
    v_mfma_f32_16x16x32_bf16 v[16:19], v[76:79], v[220:223], v[16:19]
    s_waitcnt lgkmcnt(3)
    v_mfma_f32_16x16x32_bf16 v[16:19], v[80:83], v[224:227], v[16:19]
    s_waitcnt lgkmcnt(2)
    v_mfma_f32_16x16x32_bf16 v[16:19], v[84:87], v[228:231], v[16:19]
    s_waitcnt lgkmcnt(1)
    v_mfma_f32_16x16x32_bf16 v[16:19], v[88:91], v[232:235], v[16:19]
    s_waitcnt lgkmcnt(0)
    v_mfma_f32_16x16x32_bf16 v[16:19], v[92:95], v[236:239], v[16:19]
    ds_read_b64_tr_b16 v[104:105], v9 offset:0
    ds_read_b64_tr_b16 v[106:107], v9 offset:16896
    ds_read_b64_tr_b16 v[120:121], v9 offset:32
    ds_read_b64_tr_b16 v[122:123], v9 offset:16928
    ds_read_b64_tr_b16 v[136:137], v9 offset:64
    ds_read_b64_tr_b16 v[138:139], v9 offset:16960
    ds_read_b64_tr_b16 v[152:153], v9 offset:96
    ds_read_b64_tr_b16 v[154:155], v9 offset:16992
    s_mov_b32 s9, 0x3e0293ee
    v_max3_f32 v20, v16, v17, v18
    v_max_f32 v20, v20, v19
    v_mov_b32 v21, v20
    s_nop 1
    v_permlane16_swap_b32 v20, v21
    v_max_f32 v20, v20, v21
    v_mov_b32 v21, v20
    s_nop 1
    v_permlane32_swap_b32 v20, v21
    v_max_f32 v20, v20, v21
    ds_write_b32 v11, v20
    s_waitcnt lgkmcnt(0)
    s_barrier
    ds_read_b128 v[20:23], v28
    ds_read_b128 v[12:15], v28 offset:16
    ds_read_b64_tr_b16 v[108:109], v9 offset:33792
    ds_read_b64_tr_b16 v[110:111], v9 offset:50688
    ds_read_b64_tr_b16 v[124:125], v9 offset:33824
    ds_read_b64_tr_b16 v[126:127], v9 offset:50720
    ds_read_b64_tr_b16 v[140:141], v9 offset:33856
    ds_read_b64_tr_b16 v[142:143], v9 offset:50752
    ds_read_b64_tr_b16 v[156:157], v9 offset:33888
    ds_read_b64_tr_b16 v[158:159], v9 offset:50784
    s_waitcnt lgkmcnt(9)
    v_max3_f32 v20, v20, v21, v22
    v_max_f32 v20, v20, v23
    s_waitcnt lgkmcnt(8)
    v_max3_f32 v20, v20, v12, v13
    v_max3_f32 v20, v20, v14, v15
    v_mul_f32 v20, s9, v20
    v_fma_f32 v16, v16, s9, -v20
    v_fma_f32 v17, v17, s9, -v20
    v_fma_f32 v18, v18, s9, -v20
    v_fma_f32 v19, v19, s9, -v20
    v_exp_f32 v16, v16
    v_exp_f32 v17, v17
    v_exp_f32 v18, v18
    v_exp_f32 v19, v19
    v_cvt_pk_bf16_f32 v16, v16, v17
    v_cvt_pk_bf16_f32 v17, v18, v19
    ds_write_b64 v29, v[16:17]
    s_waitcnt vmcnt(0) lgkmcnt(0)
    s_barrier
    ds_read_b128 v[160:163], v30 offset:0
    ds_read_b128 v[164:167], v30 offset:1024
    ds_read_b128 v[168:171], v30 offset:2048
    ds_read_b128 v[172:175], v30 offset:3072
    s_cmp_eq_u32 s3, 2
    s_cbranch_scc0 L_Bpv
    v_mov_b32 v12, 0x3f803f80
    v_mov_b32 v13, 0x3f803f80
    v_mov_b32 v14, 0x3f803f80
    v_mov_b32 v15, 0x3f803f80
    v_mov_b32 v21, s42
    v_mov_b32 v23, s42
    s_waitcnt lgkmcnt(0)
    v_mfma_f32_16x16x32_bf16 v[16:19], v[12:15], v[160:163], 0
    v_mfma_f32_16x16x32_bf16 v[16:19], v[12:15], v[164:167], v[16:19]
    v_mfma_f32_16x16x32_bf16 v[16:19], v[12:15], v[168:171], v[16:19]
    v_mfma_f32_16x16x32_bf16 v[16:19], v[12:15], v[172:175], v[16:19]
    s_mov_b32 exec_lo, 0xffff
    s_mov_b32 exec_hi, 0x0
    s_nop 5
    v_mov_b32 v22, v16
    buffer_store_dwordx4 v[20:23], v4, s[44:47], s11 offen sc1
    s_mov_b64 exec, -1
L_Bpv:
    v_mov_b32 v24, -2
    s_waitcnt lgkmcnt(3)
    v_mfma_f32_16x16x32_bf16 v[176:179], v[160:163], v[96:99], 0
    v_mfma_f32_16x16x32_bf16 v[180:183], v[160:163], v[112:115], 0
    v_mfma_f32_16x16x32_bf16 v[184:187], v[160:163], v[128:131], 0
    v_mfma_f32_16x16x32_bf16 v[188:191], v[160:163], v[144:147], 0
    s_waitcnt lgkmcnt(2)
    v_mfma_f32_16x16x32_bf16 v[176:179], v[164:167], v[100:103], v[176:179]
    v_mfma_f32_16x16x32_bf16 v[180:183], v[164:167], v[116:119], v[180:183]
    v_mfma_f32_16x16x32_bf16 v[184:187], v[164:167], v[132:135], v[184:187]
    v_mfma_f32_16x16x32_bf16 v[188:191], v[164:167], v[148:151], v[188:191]
    s_waitcnt lgkmcnt(1)
    v_mfma_f32_16x16x32_bf16 v[176:179], v[168:171], v[104:107], v[176:179]
    v_mfma_f32_16x16x32_bf16 v[180:183], v[168:171], v[120:123], v[180:183]
    v_mfma_f32_16x16x32_bf16 v[184:187], v[168:171], v[136:139], v[184:187]
    v_mfma_f32_16x16x32_bf16 v[188:191], v[168:171], v[152:155], v[188:191]
    s_waitcnt lgkmcnt(0)
    v_mfma_f32_16x16x32_bf16 v[176:179], v[172:175], v[108:111], v[176:179]
    v_mfma_f32_16x16x32_bf16 v[180:183], v[172:175], v[124:127], v[180:183]
    v_mfma_f32_16x16x32_bf16 v[184:187], v[172:175], v[140:143], v[184:187]
    v_mfma_f32_16x16x32_bf16 v[188:191], v[172:175], v[156:159], v[188:191]
    s_nop 5
    v_cvt_pk_bf16_f32 v192, v176, v180
    s_nop 0
    v_cvt_pk_bf16_f32 v193, v184, v188
    v_cvt_pk_bf16_f32 v194, v177, v181
    v_cvt_pk_bf16_f32 v195, v185, v189
    v_min_u32 v196, v192, v24
    v_min_u32 v197, v193, v24
    v_min_u32 v198, v194, v24
    v_min_u32 v199, v195, v24
    v_min_u32_dpp v196, v194, v24 row_ror:8 row_mask:0xf bank_mask:0xc
    v_min_u32_dpp v198, v192, v24 row_ror:8 row_mask:0xf bank_mask:0x3
    v_min_u32_dpp v197, v195, v24 row_ror:8 row_mask:0xf bank_mask:0xc
    v_min_u32_dpp v199, v193, v24 row_ror:8 row_mask:0xf bank_mask:0x3
    buffer_store_dwordx4 v[196:199], v31, s[44:47], s98 offen sc1
    v_cvt_pk_bf16_f32 v200, v178, v182
    v_cvt_pk_bf16_f32 v201, v186, v190
    v_cvt_pk_bf16_f32 v202, v179, v183
    v_cvt_pk_bf16_f32 v203, v187, v191
    v_min_u32 v204, v200, v24
    v_min_u32 v205, v201, v24
    v_min_u32 v206, v202, v24
    v_min_u32 v207, v203, v24
    v_min_u32_dpp v204, v202, v24 row_ror:8 row_mask:0xf bank_mask:0xc
    v_min_u32_dpp v206, v200, v24 row_ror:8 row_mask:0xf bank_mask:0x3
    v_min_u32_dpp v205, v203, v24 row_ror:8 row_mask:0xf bank_mask:0xc
    v_min_u32_dpp v207, v201, v24 row_ror:8 row_mask:0xf bank_mask:0x3
    buffer_store_dwordx4 v[204:207], v31, s[44:47], s99 offen sc1
    s_cmp_lt_i32 s15, 0
    s_cbranch_scc1 L_D
    s_lshl_b32 s9, s3, 11
    s_add_u32 s9, s9, 0
    s_mov_b32 m0, s9
    s_add_u32 s9, s9, 1024
    buffer_load_dwordx4 v26, s[52:55], s97 offen  lds
    s_mov_b32 m0, s9
    s_add_u32 s97, s97, 2048
    buffer_load_dwordx4 v27, s[52:55], s97 offen  lds
    v_lshrrev_b32 v5, 2, v1
    v_and_b32 v6, 7, v5
    s_lshl_b32 s10, s3, 1
    v_xor_b32 v6, s10, v6
    v_lshlrev_b32 v6, 5, v6
    v_lshl_add_u32 v6, v5, 9, v6
    v_and_b32 v5, 3, v1
    v_lshl_add_u32 v6, v5, 3, v6
    v_add_u32 v6, 0, v6
    v_xor_b32 v7, 32, v6
    v_bfe_u32 v8, v3, 2, 1
    v_lshlrev_b32 v8, 7, v8
    v_lshl_add_u32 v8, v2, 4, v8
    v_add_u32 v8, 156672, v8
    v_mul_u32_u24 v15, 229376, v2
    v_lshl_add_u32 v15, v3, 3, v15
    s_and_b32 s14, s15, 1
    s_lshl_b32 s14, s14, 3
    s_add_u32 s14, s14, s3
    s_mul_i32 s14, s14, 14336
    s_lshr_b32 s15, s15, 1
    s_lshl_b32 s13, s15, 7
    s_add_u32 s14, s14, s13
    s_add_u32 s14, s14, 0x342000
    s_cmp_eq_u32 s3, 1
    s_cbranch_scc0 L_G3
    v_lshlrev_b32 v4, 8, v2
    v_lshl_add_u32 v4, v3, 2, v4
    s_lshr_b32 s10, s15, 2
    s_lshl_b32 s10, s10, 13
    s_and_b32 s11, s15, 3
    s_lshl_b32 s11, s11, 6
    s_add_u32 s10, s10, s11
    s_add_u32 s10, s10, 0x50000
    s_add_u32 s11, s10, 4096
    s_add_u32 s12, s10, 90112
    s_add_u32 s13, s12, 4096
    v_bfe_u32 v5, v1, 2, 1
    v_lshlrev_b32 v5, 4, v5
    v_bfe_u32 v14, v1, 4, 1
    v_lshl_add_u32 v5, v14, 3, v5
    v_bfe_u32 v14, v1, 3, 1
    v_lshl_add_u32 v5, v14, 2, v5
    v_and_b32 v14, 3, v1
    v_add_u32 v5, v5, v14
    v_lshlrev_b32 v5, 1, v5
    v_lshrrev_b32 v14, 5, v1
    v_lshl_add_u32 v5, v14, 7, v5
    v_add_u32 v5, 156672, v5
    s_mov_b32 s9, 0
L_GpollG:
    buffer_load_dword v64, v4, s[44:47], s10 offen offset:0 sc1
    buffer_load_dword v65, v4, s[44:47], s10 offen offset:1024 sc1
    buffer_load_dword v66, v4, s[44:47], s10 offen offset:2048 sc1
    buffer_load_dword v67, v4, s[44:47], s10 offen offset:3072 sc1
    buffer_load_dword v68, v4, s[44:47], s11 offen offset:0 sc1
    buffer_load_dword v69, v4, s[44:47], s11 offen offset:1024 sc1
    buffer_load_dword v70, v4, s[44:47], s11 offen offset:2048 sc1
    buffer_load_dword v71, v4, s[44:47], s11 offen offset:3072 sc1
    buffer_load_dword v72, v4, s[44:47], s12 offen offset:0 sc1
    buffer_load_dword v73, v4, s[44:47], s12 offen offset:1024 sc1
    buffer_load_dword v74, v4, s[44:47], s12 offen offset:2048 sc1
    buffer_load_dword v75, v4, s[44:47], s12 offen offset:3072 sc1
    buffer_load_dword v76, v4, s[44:47], s13 offen offset:0 sc1
    buffer_load_dword v77, v4, s[44:47], s13 offen offset:1024 sc1
    buffer_load_dword v78, v4, s[44:47], s13 offen offset:2048 sc1
    buffer_load_dword v79, v4, s[44:47], s13 offen offset:3072 sc1
    s_add_u32 s9, s9, 1
    s_waitcnt vmcnt(0)
    v_xor_b32 v16, s43, v64
    v_bitop3_b32 v16, v16, v65, s43 bitop3:0xf6
    v_bitop3_b32 v16, v16, v66, s43 bitop3:0xf6
    v_bitop3_b32 v16, v16, v67, s43 bitop3:0xf6
    v_bitop3_b32 v16, v16, v68, s43 bitop3:0xf6
    v_bitop3_b32 v16, v16, v69, s43 bitop3:0xf6
    v_bitop3_b32 v16, v16, v70, s43 bitop3:0xf6
    v_bitop3_b32 v16, v16, v71, s43 bitop3:0xf6
    v_bitop3_b32 v16, v16, v72, s43 bitop3:0xf6
    v_bitop3_b32 v16, v16, v73, s43 bitop3:0xf6
    v_bitop3_b32 v16, v16, v74, s43 bitop3:0xf6
    v_bitop3_b32 v16, v16, v75, s43 bitop3:0xf6
    v_bitop3_b32 v16, v16, v76, s43 bitop3:0xf6
    v_bitop3_b32 v16, v16, v77, s43 bitop3:0xf6
    v_bitop3_b32 v16, v16, v78, s43 bitop3:0xf6
    v_bitop3_b32 v16, v16, v79, s43 bitop3:0xf6
    v_and_b32 v16, 0xff, v16
    v_cmp_ne_u32 vcc, 0, v16
    s_cmp_gt_u32 s9, 20000
    s_cbranch_scc1 L_GpollGd
    s_cbranch_vccnz L_GpollG
L_GpollGd:
    s_mov_b32 s9, 0xffffff00
    v_and_b32 v64, s9, v64
    v_and_b32 v65, s9, v65
    v_and_b32 v66, s9, v66
    v_and_b32 v67, s9, v67
    v_and_b32 v68, s9, v68
    v_and_b32 v69, s9, v69
    v_and_b32 v70, s9, v70
    v_and_b32 v71, s9, v71
    v_and_b32 v72, s9, v72
    v_and_b32 v73, s9, v73
    v_and_b32 v74, s9, v74
    v_and_b32 v75, s9, v75
    v_and_b32 v76, s9, v76
    v_and_b32 v77, s9, v77
    v_and_b32 v78, s9, v78
    v_and_b32 v79, s9, v79
    v_add_f32 v64, v64, v65
    v_add_f32 v66, v66, v67
    v_add_f32 v68, v68, v69
    v_add_f32 v70, v70, v71
    v_add_f32 v64, v64, v66
    v_add_f32 v68, v68, v70
    v_add_f32 v64, v64, v68
    v_add_f32 v72, v72, v73
    v_add_f32 v74, v74, v75
    v_add_f32 v76, v76, v77
    v_add_f32 v78, v78, v79
    v_add_f32 v72, v72, v74
    v_add_f32 v76, v76, v78
    v_add_f32 v72, v72, v76
    v_cvt_pk_bf16_f32 v16, v64, v72
    v_and_b32 v17, 0xffff0000, v16
    v_lshlrev_b32 v16, 16, v16
    v_mul_f32 v16, 0xbfb8aa3b, v16
    v_exp_f32 v16, v16
    s_nop 0
    v_add_f32 v16, 1.0, v16
    v_rcp_f32 v16, v16
    s_nop 0
    v_cvt_pk_bf16_f32 v16, v16, v16
    v_lshlrev_b32 v16, 16, v16
    v_mul_f32 v16, v16, v17
    v_cvt_pk_bf16_f32 v16, v16, v16
    ds_write_b16 v5, v16
L_G3:
    s_waitcnt vmcnt(0) lgkmcnt(0)
    s_barrier
    ds_read_b128 v[40:43], v8
    ds_read_b64_tr_b16 v[32:33], v6 offset:0
    ds_read_b64_tr_b16 v[34:35], v6 offset:8192
    ds_read_b64_tr_b16 v[36:37], v7 offset:0
    ds_read_b64_tr_b16 v[38:39], v7 offset:8192
    s_mov_b32 s9, 0xffffff00
    v_mov_b32 v16, s43
    s_waitcnt lgkmcnt(0)
    v_mfma_f32_16x16x32_bf16 v[44:47], v[40:43], v[32:35], 0
    v_mfma_f32_16x16x32_bf16 v[48:51], v[40:43], v[36:39], 0
    s_mov_b32 exec_lo, 0xffffffff
    s_mov_b32 exec_hi, 0x0
    s_nop 4
    v_and_or_b32 v18, v44, s9, v16
    v_and_or_b32 v19, v48, s9, v16
    buffer_store_dwordx2 v[18:19], v15, s[44:47], s14 offen sc1
    s_mov_b64 exec, -1
    s_branch L_fin
L_D:
    s_cmp_lg_u32 s3, 0
    s_cbranch_scc1 L_fin
    s_cmp_ge_u32 s2, 160
    s_cbranch_scc1 L_fin
    s_sub_u32 s9, s2, 128
    s_mul_i32 s10, s9, 14336
    s_add_u32 s10, s10, 0x340000
    s_add_u32 s13, s10, 4096
    s_add_u32 s14, s10, 8192
    s_add_u32 s15, s10, 12288
    s_lshl_b32 s11, s9, 6
    v_and_b32 v5, 7, v1
    v_lshlrev_b32 v5, 2, v5
    buffer_load_dword v6, v5, s[48:51], s11 offen
    buffer_load_dword v7, v5, s[48:51], s11 offen offset:32
    s_mov_b32 s9, 0xffffff00
    s_mov_b32 s12, 0
    v_mov_b32 v84, s43
    v_mov_b32 v85, s43
    v_mov_b32 v86, s43
    v_mov_b32 v87, s43
L_DpollG:
    buffer_load_dwordx4 v[64:67], v4, s[44:47], s14 offen offset:0 sc1
    buffer_load_dwordx4 v[68:71], v4, s[44:47], s14 offen offset:1024 sc1
    buffer_load_dwordx4 v[72:75], v4, s[44:47], s14 offen offset:2048 sc1
    buffer_load_dwordx4 v[76:79], v4, s[44:47], s14 offen offset:3072 sc1
    buffer_load_dwordx4 v[80:83], v4, s[44:47], s15 offen offset:0 sc1
    s_mov_b32 exec_lo, 0xffffff
    s_mov_b32 exec_hi, 0x0
    buffer_load_dwordx4 v[84:87], v4, s[44:47], s15 offen offset:1024 sc1
    s_mov_b64 exec, -1
    s_add_u32 s12, s12, 1
    s_waitcnt vmcnt(5)
    v_xor_b32 v8, s43, v64
    v_bitop3_b32 v8, v8, v65, s43 bitop3:0xf6
    v_bitop3_b32 v8, v8, v66, s43 bitop3:0xf6
    v_bitop3_b32 v8, v8, v67, s43 bitop3:0xf6
    s_waitcnt vmcnt(4)
    v_bitop3_b32 v8, v8, v68, s43 bitop3:0xf6
    v_bitop3_b32 v8, v8, v69, s43 bitop3:0xf6
    v_bitop3_b32 v8, v8, v70, s43 bitop3:0xf6
    v_bitop3_b32 v8, v8, v71, s43 bitop3:0xf6
    s_waitcnt vmcnt(3)
    v_bitop3_b32 v8, v8, v72, s43 bitop3:0xf6
    v_bitop3_b32 v8, v8, v73, s43 bitop3:0xf6
    v_bitop3_b32 v8, v8, v74, s43 bitop3:0xf6
    v_bitop3_b32 v8, v8, v75, s43 bitop3:0xf6
    s_waitcnt vmcnt(2)
    v_bitop3_b32 v8, v8, v76, s43 bitop3:0xf6
    v_bitop3_b32 v8, v8, v77, s43 bitop3:0xf6
    v_bitop3_b32 v8, v8, v78, s43 bitop3:0xf6
    v_bitop3_b32 v8, v8, v79, s43 bitop3:0xf6
    s_waitcnt vmcnt(1)
    v_bitop3_b32 v8, v8, v80, s43 bitop3:0xf6
    v_bitop3_b32 v8, v8, v81, s43 bitop3:0xf6
    v_bitop3_b32 v8, v8, v82, s43 bitop3:0xf6
    v_bitop3_b32 v8, v8, v83, s43 bitop3:0xf6
    s_waitcnt vmcnt(0)
    v_bitop3_b32 v8, v8, v84, s43 bitop3:0xf6
    v_bitop3_b32 v8, v8, v85, s43 bitop3:0xf6
    v_bitop3_b32 v8, v8, v86, s43 bitop3:0xf6
    v_bitop3_b32 v8, v8, v87, s43 bitop3:0xf6
    v_and_b32 v8, 0xff, v8
    v_cmp_ne_u32 vcc, 0, v8
    s_cmp_gt_u32 s12, 20000
    s_cbranch_scc1 L_DpollGd
    s_cbranch_vccnz L_DpollG
L_DpollGd:
    v_and_b32 v64, s9, v64
    v_and_b32 v65, s9, v65
    v_and_b32 v66, s9, v66
    v_and_b32 v67, s9, v67
    v_and_b32 v68, s9, v68
    v_and_b32 v69, s9, v69
    v_and_b32 v70, s9, v70
    v_and_b32 v71, s9, v71
    v_and_b32 v72, s9, v72
    v_and_b32 v73, s9, v73
    v_and_b32 v74, s9, v74
    v_and_b32 v75, s9, v75
    v_and_b32 v76, s9, v76
    v_and_b32 v77, s9, v77
    v_and_b32 v78, s9, v78
    v_and_b32 v79, s9, v79
    v_and_b32 v80, s9, v80
    v_and_b32 v81, s9, v81
    v_and_b32 v82, s9, v82
    v_and_b32 v83, s9, v83
    v_and_b32 v84, s9, v84
    v_and_b32 v85, s9, v85
    v_and_b32 v86, s9, v86
    v_and_b32 v87, s9, v87
    v_pk_add_f32 v[64:65], v[64:65], v[68:69]
    v_pk_add_f32 v[72:73], v[72:73], v[76:77]
    v_pk_add_f32 v[80:81], v[80:81], v[84:85]
    v_pk_add_f32 v[64:65], v[64:65], v[72:73]
    v_pk_add_f32 v[64:65], v[64:65], v[80:81]
    v_pk_add_f32 v[66:67], v[66:67], v[70:71]
    v_pk_add_f32 v[74:75], v[74:75], v[78:79]
    v_pk_add_f32 v[82:83], v[82:83], v[86:87]
    v_pk_add_f32 v[66:67], v[66:67], v[74:75]
    v_pk_add_f32 v[66:67], v[66:67], v[82:83]
L_Dpoll:
    buffer_load_dwordx4 v[32:35], v4, s[44:47], s10 offen offset:0 sc1
    buffer_load_dwordx4 v[36:39], v4, s[44:47], s10 offen offset:1024 sc1
    buffer_load_dwordx4 v[40:43], v4, s[44:47], s10 offen offset:2048 sc1
    buffer_load_dwordx4 v[44:47], v4, s[44:47], s10 offen offset:3072 sc1
    buffer_load_dwordx4 v[48:51], v4, s[44:47], s13 offen offset:0 sc1
    buffer_load_dwordx4 v[52:55], v4, s[44:47], s13 offen offset:1024 sc1
    buffer_load_dwordx4 v[56:59], v4, s[44:47], s13 offen offset:2048 sc1
    buffer_load_dwordx4 v[60:63], v4, s[44:47], s13 offen offset:3072 sc1
    s_add_u32 s12, s12, 1
    s_waitcnt vmcnt(7)
    v_xor_b32 v8, s43, v32
    v_bitop3_b32 v8, v8, v33, s43 bitop3:0xf6
    v_bitop3_b32 v8, v8, v34, s43 bitop3:0xf6
    v_bitop3_b32 v8, v8, v35, s43 bitop3:0xf6
    s_waitcnt vmcnt(6)
    v_bitop3_b32 v8, v8, v36, s43 bitop3:0xf6
    v_bitop3_b32 v8, v8, v37, s43 bitop3:0xf6
    v_bitop3_b32 v8, v8, v38, s43 bitop3:0xf6
    v_bitop3_b32 v8, v8, v39, s43 bitop3:0xf6
    s_waitcnt vmcnt(5)
    v_bitop3_b32 v8, v8, v40, s43 bitop3:0xf6
    v_bitop3_b32 v8, v8, v41, s43 bitop3:0xf6
    v_bitop3_b32 v8, v8, v42, s43 bitop3:0xf6
    v_bitop3_b32 v8, v8, v43, s43 bitop3:0xf6
    s_waitcnt vmcnt(4)
    v_bitop3_b32 v8, v8, v44, s43 bitop3:0xf6
    v_bitop3_b32 v8, v8, v45, s43 bitop3:0xf6
    v_bitop3_b32 v8, v8, v46, s43 bitop3:0xf6
    v_bitop3_b32 v8, v8, v47, s43 bitop3:0xf6
    s_waitcnt vmcnt(3)
    v_bitop3_b32 v8, v8, v48, s43 bitop3:0xf6
    v_bitop3_b32 v8, v8, v49, s43 bitop3:0xf6
    v_bitop3_b32 v8, v8, v50, s43 bitop3:0xf6
    v_bitop3_b32 v8, v8, v51, s43 bitop3:0xf6
    s_waitcnt vmcnt(2)
    v_bitop3_b32 v8, v8, v52, s43 bitop3:0xf6
    v_bitop3_b32 v8, v8, v53, s43 bitop3:0xf6
    v_bitop3_b32 v8, v8, v54, s43 bitop3:0xf6
    v_bitop3_b32 v8, v8, v55, s43 bitop3:0xf6
    s_waitcnt vmcnt(1)
    v_bitop3_b32 v8, v8, v56, s43 bitop3:0xf6
    v_bitop3_b32 v8, v8, v57, s43 bitop3:0xf6
    v_bitop3_b32 v8, v8, v58, s43 bitop3:0xf6
    v_bitop3_b32 v8, v8, v59, s43 bitop3:0xf6
    s_waitcnt vmcnt(0)
    v_bitop3_b32 v8, v8, v60, s43 bitop3:0xf6
    v_bitop3_b32 v8, v8, v61, s43 bitop3:0xf6
    v_bitop3_b32 v8, v8, v62, s43 bitop3:0xf6
    v_bitop3_b32 v8, v8, v63, s43 bitop3:0xf6
    v_and_b32 v8, 0xff, v8
    v_cmp_ne_u32 vcc, 0, v8
    s_cmp_gt_u32 s12, 20000
    s_cbranch_scc1 L_Dpolld
    s_cbranch_vccnz L_Dpoll
L_Dpolld:
    v_and_b32 v32, s9, v32
    v_and_b32 v33, s9, v33
    v_and_b32 v34, s9, v34
    v_and_b32 v35, s9, v35
    v_and_b32 v36, s9, v36
    v_and_b32 v37, s9, v37
    v_and_b32 v38, s9, v38
    v_and_b32 v39, s9, v39
    v_and_b32 v40, s9, v40
    v_and_b32 v41, s9, v41
    v_and_b32 v42, s9, v42
    v_and_b32 v43, s9, v43
    v_and_b32 v44, s9, v44
    v_and_b32 v45, s9, v45
    v_and_b32 v46, s9, v46
    v_and_b32 v47, s9, v47
    v_and_b32 v48, s9, v48
    v_and_b32 v49, s9, v49
    v_and_b32 v50, s9, v50
    v_and_b32 v51, s9, v51
    v_and_b32 v52, s9, v52
    v_and_b32 v53, s9, v53
    v_and_b32 v54, s9, v54
    v_and_b32 v55, s9, v55
    v_and_b32 v56, s9, v56
    v_and_b32 v57, s9, v57
    v_and_b32 v58, s9, v58
    v_and_b32 v59, s9, v59
    v_and_b32 v60, s9, v60
    v_and_b32 v61, s9, v61
    v_and_b32 v62, s9, v62
    v_and_b32 v63, s9, v63
    v_pk_add_f32 v[32:33], v[32:33], v[36:37]
    v_pk_add_f32 v[34:35], v[34:35], v[38:39]
    v_pk_add_f32 v[40:41], v[40:41], v[44:45]
    v_pk_add_f32 v[42:43], v[42:43], v[46:47]
    v_pk_add_f32 v[48:49], v[48:49], v[52:53]
    v_pk_add_f32 v[50:51], v[50:51], v[54:55]
    v_pk_add_f32 v[56:57], v[56:57], v[60:61]
    v_pk_add_f32 v[58:59], v[58:59], v[62:63]
    v_pk_add_f32 v[32:33], v[32:33], v[40:41]
    v_pk_add_f32 v[34:35], v[34:35], v[42:43]
    v_pk_add_f32 v[48:49], v[48:49], v[56:57]
    v_pk_add_f32 v[50:51], v[50:51], v[58:59]
    v_pk_add_f32 v[32:33], v[32:33], v[48:49]
    v_pk_add_f32 v[34:35], v[34:35], v[50:51]
    v_pk_add_f32 v[32:33], v[32:33], v[64:65]
    v_pk_add_f32 v[34:35], v[34:35], v[66:67]
    s_nop 0
    v_add_f32_dpp v32, v32, v32 row_ror:8 row_mask:0xf bank_mask:0xf
    v_add_f32_dpp v33, v33, v33 row_ror:8 row_mask:0xf bank_mask:0xf
    v_add_f32_dpp v34, v34, v34 row_ror:8 row_mask:0xf bank_mask:0xf
    v_add_f32_dpp v35, v35, v35 row_ror:8 row_mask:0xf bank_mask:0xf
    v_mov_b32 v36, v32
    v_mov_b32 v37, v33
    v_mov_b32 v38, v34
    v_mov_b32 v39, v35
    v_permlane16_swap_b32 v32, v36
    v_permlane16_swap_b32 v33, v37
    v_permlane16_swap_b32 v34, v38
    v_permlane16_swap_b32 v35, v39
    v_add_f32 v32, v32, v36
    v_add_f32 v33, v33, v37
    v_add_f32 v34, v34, v38
    v_add_f32 v35, v35, v39
    v_mov_b32 v36, v32
    v_mov_b32 v37, v33
    v_mov_b32 v38, v34
    v_mov_b32 v39, v35
    v_permlane32_swap_b32 v32, v36
    v_permlane32_swap_b32 v33, v37
    v_permlane32_swap_b32 v34, v38
    v_permlane32_swap_b32 v35, v39
    v_add_f32 v32, v32, v36
    v_add_f32 v33, v33, v37
    v_add_f32 v34, v34, v38
    v_add_f32 v35, v35, v39
    v_lshlrev_b32 v36, 16, v6
    v_and_b32 v38, 0xffff0000, v6
    v_lshlrev_b32 v37, 16, v7
    v_and_b32 v39, 0xffff0000, v7
    v_add_f32 v32, v32, v36
    v_add_f32 v33, v33, v37
    v_add_f32 v34, v34, v38
    v_add_f32 v35, v35, v39
    v_cvt_pk_bf16_f32 v32, v32, v34
    v_cvt_pk_bf16_f32 v33, v33, v35
    s_mov_b32 exec_lo, 0xff
    s_mov_b32 exec_hi, 0x0
    buffer_store_dword v32, v5, s[56:59], s11 offen
    buffer_store_dword v33, v5, s[56:59], s11 offen offset:32
    s_cmp_lg_u32 s2, 128
    s_cbranch_scc1 L_Dend
    s_mov_b32 exec_lo, 0x1
    s_mov_b32 exec_hi, 0x0
    v_mov_b32 v8, s42
    v_mov_b32 v9, 0
    buffer_store_dword v8, v9, s[44:47], 0 offen offset:0 sc1
L_Dend:
    s_mov_b64 exec, -1
L_fin:
L_end:
    s_endpgm
.section .rodata,"a"
.p2align 6
.amdhsa_kernel parallel_sum__compressed_kv_cla__glu_gated_glu__decode_kernel
  .amdhsa_next_free_vgpr 256
  .amdhsa_next_free_sgpr 100
  .amdhsa_accum_offset 256
  .amdhsa_group_segment_fixed_size 0
  .amdhsa_kernarg_size 104
  .amdhsa_user_sgpr_count 2
  .amdhsa_user_sgpr_kernarg_segment_ptr 1
  .amdhsa_system_sgpr_workgroup_id_x 1
.end_amdhsa_kernel
```
